```python
import torch

def _softmax(x, axis=-1):
    return torch.softmax(x, dim=axis)
def _gelu(x):
    return torch.nn.functional.gelu(x, approximate="tanh")
def _silu(x):
    return torch.nn.functional.silu(x)
def _sigmoid(x):
    return torch.sigmoid(x)
def _layernorm(x, axis=-1, eps=1e-5):
    m = x.mean(dim=axis, keepdim=True)
    v = x.var(dim=axis, keepdim=True, unbiased=False)
    return (x - m) / torch.sqrt(v + eps)
def _scatter_add(tgt, idx, src, axis=0):
    return tgt.clone().index_add_(axis, idx, src)
def _segment_sum(src, seg, n):
    out = torch.zeros((n,) + src.shape[1:], dtype=src.dtype)
    return out.index_add_(0, seg, src)
def _pad(x, pw):
    flat = tuple(v for pair in reversed(pw) for v in pair)
    return torch.nn.functional.pad(x, flat)

kernel_name = 'concat_heads__grouped_kv_mqa__mha_block__prompt'

def setup_inputs():

    _w = (lambda a: (lambda t: t.to(torch.bfloat16) if t.is_floating_point() else t)(torch.as_tensor(a)))
    def _A_setup():
        B, S, D, H = 1, 2048, 640, 32
        Dh = D // H
        return {
            "x": _w((lambda *s: torch.randn(*s, dtype=torch.bfloat16) * 0.05)(B, S, D)),
            "wq": _w((lambda *s: torch.randn(*s, dtype=torch.bfloat16) * 0.8)(D, H * Dh)),
            "wk": _w((lambda *s: torch.randn(*s, dtype=torch.bfloat16) * 0.8)(D, Dh)),
            "wv": _w((lambda *s: torch.randn(*s, dtype=torch.bfloat16) * 0.1)(D, Dh)),
            "wo": _w((lambda *s: torch.randn(*s, dtype=torch.bfloat16) * 0.1)(H * Dh, D)),
        }
    _A_in = _A_setup()

    def _B_setup():
        B, S, D, H = 1, 2048, 640, 32
        return {
            "x": _w((lambda *s: torch.randn(*s, dtype=torch.bfloat16) * 0.2)(B, S, D)),
            "wqkv": _w((lambda *s: torch.randn(*s, dtype=torch.bfloat16) * 0.2)(D, 3 * D)),
            "wo": _w((lambda *s: torch.randn(*s, dtype=torch.bfloat16) * 0.05)(D, D)),
        }
    _B_in = _B_setup()

    return {
        "A_x": _A_in["x"],
        "A_wq": _A_in["wq"],
        "A_wk": _A_in["wk"],
        "A_wv": _A_in["wv"],
        "A_wo": _A_in["wo"],
        "B_x": _B_in["x"],
        "B_wqkv": _B_in["wqkv"],
        "B_wo": _B_in["wo"],
    }

def reference(A_x, A_wq, A_wk, A_wv, A_wo, B_x, B_wqkv, B_wo):
    def _A_ref(x, wq, wk, wv, wo):
        B, S, D = x.shape
        H = 32
        Dh = D // H
        q = (lambda x, *d: x.permute(*d))((x @ wq).reshape(B, S, H, Dh), 0, 2, 1, 3)
        k = x @ wk
        v = x @ wv
        scores = torch.einsum("bhqd,bkd->bhqk", q, k) * (Dh ** -0.5)
        p = _softmax(scores, axis=-1)
        o = torch.einsum("bhqk,bkd->bhqd", p, v)
        return (lambda x, *d: x.permute(*d))(o, 0, 2, 1, 3).reshape(B, S, H * Dh) @ wo

    def _B_ref(x, wqkv, wo):
        B, S, D = x.shape
        H = 32
        Dh = D // H
        qkv = (lambda x, *d: x.permute(*d))((x @ wqkv).reshape(B, S, 3, H, Dh), 2, 0, 3, 1, 4)
        q, k, v = qkv[0], qkv[1], qkv[2]
        scores = torch.einsum("bhqd,bhkd->bhqk", q, k) * (Dh ** -0.5)
        p = _softmax(scores, axis=-1)
        o = torch.einsum("bhqk,bhkd->bhqd", p, v)
        return (lambda x, *d: x.permute(*d))(o, 0, 2, 1, 3).reshape(B, S, D) @ wo

    a = _A_ref(A_x, A_wq, A_wk, A_wv, A_wo)
    b = _B_ref(B_x, B_wqkv, B_wo)
    return torch.concatenate([a, b], axis=-1)
```

```asm
; @launch kernel=proj_kernel grid=(256,1,1) block=(512,1,1) lds=158720
; @launch kernel=attn_kernel grid=(256,1,1) block=(512,1,1) lds=163840
; @launch kernel=outp_kernel grid=(256,1,1) block=(512,1,1) lds=102400
.amdgcn_target "amdgcn-amd-amdhsa--gfx950"
.text
.globl proj_kernel
.p2align 8
.type proj_kernel,@function
proj_kernel:
  s_cmp_ge_u32 s2, 256
  s_cbranch_scc1 L_proj_kernel_end
  s_load_dwordx2 s[48:49], s[0:1], 0
  s_load_dwordx2 s[50:51], s[0:1], 8
  s_load_dwordx4 s[52:55], s[0:1], 16
  s_load_dwordx4 s[56:59], s[0:1], 40
  s_load_dwordx2 s[24:25], s[0:1], 80
  v_lshrrev_b32 v1, 6, v0
  v_and_b32 v0, 63, v0
  v_readfirstlane_b32 s20, v1
  s_and_b32 s32, s2, 7
  s_lshr_b32 s33, s2, 3
  s_lshr_b32 s21, s32, 1
  s_and_b32 s34, s32, 1
  s_lshl_b32 s34, s34, 3
  s_lshr_b32 s35, s33, 2
  s_add_u32 s22, s34, s35
  s_and_b32 s23, s33, 3
  s_cmp_eq_u32 s21, 0
  s_movk_i32 s26, 3840
  s_cselect_b32 s26, 1280, s26
  s_cmp_ge_u32 s20, 4
  s_cbranch_scc0 L_proj_kernel_cons
  s_setprio 3
  s_sub_u32 s41, s20, 4
  v_lshrrev_b32 v4, 3, v0
  v_and_b32 v5, 7, v0
  v_lshrrev_b32 v6, 4, v0
  v_mul_u32_u24 v4, 1280, v4
  v_xor_b32 v7, v5, v6
  v_lshl_add_u32 v2, v7, 4, v4
  v_xor_b32 v7, 4, v7
  v_lshl_add_u32 v3, v7, 4, v4
  v_add_u32 v64, 18432, v2
  v_add_u32 v63, 9216, v3
  v_add_u32 v65, 27648, v3
  s_lshl_b32 s27, s22, 7
  s_lshl_b32 s32, s41, 5
  s_add_u32 s27, s27, s32
  s_mul_i32 s27, s27, 1280
  s_max_u32 s32, s21, 1
  s_sub_u32 s32, s32, 1
  s_mul_i32 s32, s32, 1280
  s_mul_i32 s33, s23, 320
  s_add_u32 s32, s32, s33
  s_lshl_b32 s33, s41, 4
  s_mul_i32 s33, s33, s26
  s_add_u32 s28, s32, s33
  s_lshl_b32 s42, s26, 6
  s_lshl_b32 s43, s41, 12
  s_mul_i32 s44, s41, 5120
  s_add_u32 s44, s44, 16384
  s_mul_i32 s45, s41, 640
  s_add_u32 s45, s45, 36864
  s_mov_b32 s30, 0
  s_and_b32 s74, s2, 1
  s_mul_i32 s74, s74, 5
  s_max_u32 s32, s21, 1
  s_sub_u32 s32, s32, 1
  s_mul_i32 s32, s32, 3
  s_add_u32 s74, s74, s32
  s_cmp_ge_u32 s74, 10
  s_cselect_b32 s32, 10, 0
  s_sub_u32 s74, s74, s32
  s_lshl_b32 s32, s74, 7
  s_add_u32 s27, s27, s32
  s_mul_i32 s32, s74, s42
  s_add_u32 s28, s28, s32
  v_lshlrev_b32 v13, 4, v0
  s_mul_i32 s29, s41, 640
  s_mul_i32 s32, s74, 2560
  s_add_u32 s29, s29, s32
  s_waitcnt lgkmcnt(0)
  s_cmp_eq_u32 s21, 0
  s_cselect_b32 s4, s48, s56
  s_cselect_b32 s5, s49, s57
  s_cselect_b32 s8, s50, s58
  s_cselect_b32 s9, s51, s59
  s_and_b32 s5, s5, 0xffff
  s_mov_b32 s6, 2621440
  s_mov_b32 s7, 0x20000
  s_and_b32 s9, s9, 0xffff
  s_mul_i32 s10, s26, 640
  s_mov_b32 s11, 0x20000
  s_mov_b32 s64, 4294966144
  s_movk_i32 s65, 128
  s_sub_u32 s66, s42, s10
  s_mov_b32 s67, 4294944256
  s_movk_i32 s68, 2560
  s_cmp_eq_u32 s21, 0
  s_cbranch_scc1 L_proj_kernel_prodA
  s_add_u32 m0, s30, s43
  s_nop 0
  buffer_load_dwordx4 v2, s[4:7], s27 offen offset:0 lds
  buffer_load_dwordx4 v63, s[4:7], s27 offen offset:1024 lds
  buffer_load_dwordx4 v64, s[4:7], s27 offen offset:2048 lds
  buffer_load_dwordx4 v65, s[4:7], s27 offen offset:3072 lds
  v_add_u32 v4, 0, v0
  v_mul_u32_u24 v5, 3277, v4
  v_lshrrev_b32 v5, 16, v5
  v_mul_u32_u24 v6, 20, v5
  v_sub_u32 v6, v4, v6
  v_lshrrev_b32 v7, 3, v5
  v_lshlrev_b32 v7, 1, v7
  v_sub_u32 v6, v6, v7
  v_add_u32 v7, 20, v6
  v_cmp_gt_i32 vcc, 0, v6
  v_mul_u32_u24 v5, s26, v5
  s_nop 0
  v_cndmask_b32 v6, v6, v7, vcc
  v_lshl_add_u32 v8, v6, 4, v5
  v_add_u32 v4, 64, v0
  v_mul_u32_u24 v5, 3277, v4
  v_lshrrev_b32 v5, 16, v5
  v_mul_u32_u24 v6, 20, v5
  v_sub_u32 v6, v4, v6
  v_lshrrev_b32 v7, 3, v5
  v_lshlrev_b32 v7, 1, v7
  v_sub_u32 v6, v6, v7
  v_add_u32 v7, 20, v6
  v_cmp_gt_i32 vcc, 0, v6
  v_mul_u32_u24 v5, s26, v5
  s_nop 0
  v_cndmask_b32 v6, v6, v7, vcc
  v_lshl_add_u32 v9, v6, 4, v5
  v_subrev_u32 v9, 1024, v9
  v_add_u32 v4, 128, v0
  v_mul_u32_u24 v5, 3277, v4
  v_lshrrev_b32 v5, 16, v5
  v_mul_u32_u24 v6, 20, v5
  v_sub_u32 v6, v4, v6
  v_lshrrev_b32 v7, 3, v5
  v_lshlrev_b32 v7, 1, v7
  v_sub_u32 v6, v6, v7
  v_add_u32 v7, 20, v6
  v_cmp_gt_i32 vcc, 0, v6
  v_mul_u32_u24 v5, s26, v5
  s_nop 0
  v_cndmask_b32 v6, v6, v7, vcc
  v_lshl_add_u32 v10, v6, 4, v5
  v_subrev_u32 v10, 2048, v10
  v_add_u32 v4, 192, v0
  v_mul_u32_u24 v5, 3277, v4
  v_lshrrev_b32 v5, 16, v5
  v_mul_u32_u24 v6, 20, v5
  v_sub_u32 v6, v4, v6
  v_lshrrev_b32 v7, 3, v5
  v_lshlrev_b32 v7, 1, v7
  v_sub_u32 v6, v6, v7
  v_add_u32 v7, 20, v6
  v_cmp_gt_i32 vcc, 0, v6
  v_mul_u32_u24 v5, s26, v5
  s_nop 0
  v_cndmask_b32 v6, v6, v7, vcc
  v_lshl_add_u32 v11, v6, 4, v5
  v_subrev_u32 v11, 3072, v11
  v_add_u32 v4, 256, v0
  v_mul_u32_u24 v5, 3277, v4
  v_lshrrev_b32 v5, 16, v5
  v_mul_u32_u24 v6, 20, v5
  v_sub_u32 v6, v4, v6
  v_lshrrev_b32 v7, 3, v5
  v_lshlrev_b32 v7, 1, v7
  v_sub_u32 v6, v6, v7
  v_add_u32 v7, 20, v6
  v_cmp_gt_i32 vcc, 0, v6
  v_mul_u32_u24 v5, s26, v5
  s_nop 0
  v_cndmask_b32 v6, v6, v7, vcc
  v_lshl_add_u32 v12, v6, 4, v5
  s_add_u32 m0, s30, s44
  s_nop 0
  buffer_load_dwordx4 v8, s[8:11], s28 offen offset:0 lds
  buffer_load_dwordx4 v9, s[8:11], s28 offen offset:1024 lds
  buffer_load_dwordx4 v10, s[8:11], s28 offen offset:2048 lds
  buffer_load_dwordx4 v11, s[8:11], s28 offen offset:3072 lds
  s_add_u32 m0, m0, 4096
  s_nop 0
  buffer_load_dwordx4 v12, s[8:11], s28 offen lds
  s_add_u32 s74, s74, 1
  s_cmp_eq_u32 s74, 10
  s_cselect_b32 s74, 0, s74
  s_cselect_b32 s46, s64, s65
  s_cselect_b32 s75, s66, s42
  s_add_u32 s27, s27, s46
  s_add_u32 s28, s28, s75
  s_add_u32 s30, s30, 39424
  s_cmp_eq_u32 s30, 157696
  s_cselect_b32 s30, 0, s30
  s_add_u32 m0, s30, s43
  s_nop 0
  buffer_load_dwordx4 v2, s[4:7], s27 offen offset:0 lds
  buffer_load_dwordx4 v63, s[4:7], s27 offen offset:1024 lds
  buffer_load_dwordx4 v64, s[4:7], s27 offen offset:2048 lds
  buffer_load_dwordx4 v65, s[4:7], s27 offen offset:3072 lds
  s_add_u32 m0, s30, s44
  s_nop 0
  buffer_load_dwordx4 v8, s[8:11], s28 offen offset:0 lds
  buffer_load_dwordx4 v9, s[8:11], s28 offen offset:1024 lds
  buffer_load_dwordx4 v10, s[8:11], s28 offen offset:2048 lds
  buffer_load_dwordx4 v11, s[8:11], s28 offen offset:3072 lds
  s_add_u32 m0, m0, 4096
  s_nop 0
  buffer_load_dwordx4 v12, s[8:11], s28 offen lds
  s_add_u32 s74, s74, 1
  s_cmp_eq_u32 s74, 10
  s_cselect_b32 s74, 0, s74
  s_cselect_b32 s46, s64, s65
  s_cselect_b32 s75, s66, s42
  s_add_u32 s27, s27, s46
  s_add_u32 s28, s28, s75
  s_add_u32 s30, s30, 39424
  s_cmp_eq_u32 s30, 157696
  s_cselect_b32 s30, 0, s30
  s_waitcnt vmcnt(9)
  s_barrier
  s_add_u32 m0, s30, s43
  s_nop 0
  buffer_load_dwordx4 v2, s[4:7], s27 offen offset:0 lds
  buffer_load_dwordx4 v63, s[4:7], s27 offen offset:1024 lds
  buffer_load_dwordx4 v64, s[4:7], s27 offen offset:2048 lds
  buffer_load_dwordx4 v65, s[4:7], s27 offen offset:3072 lds
  s_add_u32 m0, s30, s44
  s_nop 0
  buffer_load_dwordx4 v8, s[8:11], s28 offen offset:0 lds
  buffer_load_dwordx4 v9, s[8:11], s28 offen offset:1024 lds
  buffer_load_dwordx4 v10, s[8:11], s28 offen offset:2048 lds
  buffer_load_dwordx4 v11, s[8:11], s28 offen offset:3072 lds
  s_add_u32 m0, m0, 4096
  s_nop 0
  buffer_load_dwordx4 v12, s[8:11], s28 offen lds
  s_add_u32 s74, s74, 1
  s_cmp_eq_u32 s74, 10
  s_cselect_b32 s74, 0, s74
  s_cselect_b32 s46, s64, s65
  s_cselect_b32 s75, s66, s42
  s_add_u32 s27, s27, s46
  s_add_u32 s28, s28, s75
  s_add_u32 s30, s30, 39424
  s_cmp_eq_u32 s30, 157696
  s_cselect_b32 s30, 0, s30
  s_mov_b32 s31, 0
L_proj_kernel_ploop:
  s_waitcnt vmcnt(9)
  s_barrier
  s_add_u32 m0, s30, s43
  s_nop 0
  buffer_load_dwordx4 v2, s[4:7], s27 offen offset:0 lds
  buffer_load_dwordx4 v63, s[4:7], s27 offen offset:1024 lds
  buffer_load_dwordx4 v64, s[4:7], s27 offen offset:2048 lds
  buffer_load_dwordx4 v65, s[4:7], s27 offen offset:3072 lds
  s_add_u32 m0, s30, s44
  s_nop 0
  buffer_load_dwordx4 v8, s[8:11], s28 offen offset:0 lds
  buffer_load_dwordx4 v9, s[8:11], s28 offen offset:1024 lds
  buffer_load_dwordx4 v10, s[8:11], s28 offen offset:2048 lds
  buffer_load_dwordx4 v11, s[8:11], s28 offen offset:3072 lds
  s_add_u32 m0, m0, 4096
  s_nop 0
  buffer_load_dwordx4 v12, s[8:11], s28 offen lds
  s_add_u32 s74, s74, 1
  s_cmp_eq_u32 s74, 10
  s_cselect_b32 s74, 0, s74
  s_cselect_b32 s46, s64, s65
  s_cselect_b32 s75, s66, s42
  s_add_u32 s27, s27, s46
  s_add_u32 s28, s28, s75
  s_add_u32 s30, s30, 39424
  s_cmp_eq_u32 s30, 157696
  s_cselect_b32 s30, 0, s30
  s_add_u32 s31, s31, 1
  s_cmp_lt_u32 s31, 7
  s_cbranch_scc1 L_proj_kernel_ploop
  s_waitcnt vmcnt(9)
  s_barrier
  s_waitcnt vmcnt(0)
  s_barrier
  s_endpgm
L_proj_kernel_prodA:
  s_cmp_lt_u32 s23, 2
  s_cselect_b32 s12, s52, s54
  s_cselect_b32 s13, s53, s55
  s_and_b32 s13, s13, 0xffff
  s_mov_b32 s14, 25600
  s_mov_b32 s15, 0x20000
  s_add_u32 m0, s30, s43
  s_nop 0
  buffer_load_dwordx4 v2, s[4:7], s27 offen offset:0 lds
  buffer_load_dwordx4 v63, s[4:7], s27 offen offset:1024 lds
  buffer_load_dwordx4 v64, s[4:7], s27 offen offset:2048 lds
  buffer_load_dwordx4 v65, s[4:7], s27 offen offset:3072 lds
  v_add_u32 v4, 0, v0
  v_mul_u32_u24 v5, 3277, v4
  v_lshrrev_b32 v5, 16, v5
  v_mul_u32_u24 v6, 20, v5
  v_sub_u32 v6, v4, v6
  v_lshrrev_b32 v7, 3, v5
  v_lshlrev_b32 v7, 1, v7
  v_sub_u32 v6, v6, v7
  v_add_u32 v7, 20, v6
  v_cmp_gt_i32 vcc, 0, v6
  v_mul_u32_u24 v5, s26, v5
  s_nop 0
  v_cndmask_b32 v6, v6, v7, vcc
  v_lshl_add_u32 v8, v6, 4, v5
  v_add_u32 v4, 64, v0
  v_mul_u32_u24 v5, 3277, v4
  v_lshrrev_b32 v5, 16, v5
  v_mul_u32_u24 v6, 20, v5
  v_sub_u32 v6, v4, v6
  v_lshrrev_b32 v7, 3, v5
  v_lshlrev_b32 v7, 1, v7
  v_sub_u32 v6, v6, v7
  v_add_u32 v7, 20, v6
  v_cmp_gt_i32 vcc, 0, v6
  v_mul_u32_u24 v5, s26, v5
  s_nop 0
  v_cndmask_b32 v6, v6, v7, vcc
  v_lshl_add_u32 v9, v6, 4, v5
  v_subrev_u32 v9, 1024, v9
  v_add_u32 v4, 128, v0
  v_mul_u32_u24 v5, 3277, v4
  v_lshrrev_b32 v5, 16, v5
  v_mul_u32_u24 v6, 20, v5
  v_sub_u32 v6, v4, v6
  v_lshrrev_b32 v7, 3, v5
  v_lshlrev_b32 v7, 1, v7
  v_sub_u32 v6, v6, v7
  v_add_u32 v7, 20, v6
  v_cmp_gt_i32 vcc, 0, v6
  v_mul_u32_u24 v5, s26, v5
  s_nop 0
  v_cndmask_b32 v6, v6, v7, vcc
  v_lshl_add_u32 v10, v6, 4, v5
  v_subrev_u32 v10, 2048, v10
  v_add_u32 v4, 192, v0
  v_mul_u32_u24 v5, 3277, v4
  v_lshrrev_b32 v5, 16, v5
  v_mul_u32_u24 v6, 20, v5
  v_sub_u32 v6, v4, v6
  v_lshrrev_b32 v7, 3, v5
  v_lshlrev_b32 v7, 1, v7
  v_sub_u32 v6, v6, v7
  v_add_u32 v7, 20, v6
  v_cmp_gt_i32 vcc, 0, v6
  v_mul_u32_u24 v5, s26, v5
  s_nop 0
  v_cndmask_b32 v6, v6, v7, vcc
  v_lshl_add_u32 v11, v6, 4, v5
  v_subrev_u32 v11, 3072, v11
  v_add_u32 v4, 256, v0
  v_mul_u32_u24 v5, 3277, v4
  v_lshrrev_b32 v5, 16, v5
  v_mul_u32_u24 v6, 20, v5
  v_sub_u32 v6, v4, v6
  v_lshrrev_b32 v7, 3, v5
  v_lshlrev_b32 v7, 1, v7
  v_sub_u32 v6, v6, v7
  v_add_u32 v7, 20, v6
  v_cmp_gt_i32 vcc, 0, v6
  v_mul_u32_u24 v5, s26, v5
  s_nop 0
  v_cndmask_b32 v6, v6, v7, vcc
  v_lshl_add_u32 v12, v6, 4, v5
  s_add_u32 m0, s30, s44
  s_nop 0
  buffer_load_dwordx4 v8, s[8:11], s28 offen offset:0 lds
  buffer_load_dwordx4 v9, s[8:11], s28 offen offset:1024 lds
  buffer_load_dwordx4 v10, s[8:11], s28 offen offset:2048 lds
  buffer_load_dwordx4 v11, s[8:11], s28 offen offset:3072 lds
  s_add_u32 m0, m0, 4096
  s_nop 0
  buffer_load_dwordx4 v12, s[8:11], s28 offen lds
  s_add_u32 m0, s30, s45
  s_mov_b32 exec_hi, 0xff
  buffer_load_dwordx4 v13, s[12:15], s29 offen lds
  s_mov_b64 exec, -1
  s_add_u32 s74, s74, 1
  s_cmp_eq_u32 s74, 10
  s_cselect_b32 s74, 0, s74
  s_cselect_b32 s46, s64, s65
  s_cselect_b32 s75, s66, s42
  s_cselect_b32 s70, s67, s68
  s_add_u32 s27, s27, s46
  s_add_u32 s28, s28, s75
  s_add_u32 s29, s29, s70
  s_add_u32 s30, s30, 39424
  s_cmp_eq_u32 s30, 157696
  s_cselect_b32 s30, 0, s30
  s_add_u32 m0, s30, s43
  s_nop 0
  buffer_load_dwordx4 v2, s[4:7], s27 offen offset:0 lds
  buffer_load_dwordx4 v63, s[4:7], s27 offen offset:1024 lds
  buffer_load_dwordx4 v64, s[4:7], s27 offen offset:2048 lds
  buffer_load_dwordx4 v65, s[4:7], s27 offen offset:3072 lds
  s_add_u32 m0, s30, s44
  s_nop 0
  buffer_load_dwordx4 v8, s[8:11], s28 offen offset:0 lds
  buffer_load_dwordx4 v9, s[8:11], s28 offen offset:1024 lds
  buffer_load_dwordx4 v10, s[8:11], s28 offen offset:2048 lds
  buffer_load_dwordx4 v11, s[8:11], s28 offen offset:3072 lds
  s_add_u32 m0, m0, 4096
  s_nop 0
  buffer_load_dwordx4 v12, s[8:11], s28 offen lds
  s_add_u32 m0, s30, s45
  s_mov_b32 exec_hi, 0xff
  buffer_load_dwordx4 v13, s[12:15], s29 offen lds
  s_mov_b64 exec, -1
  s_add_u32 s74, s74, 1
  s_cmp_eq_u32 s74, 10
  s_cselect_b32 s74, 0, s74
  s_cselect_b32 s46, s64, s65
  s_cselect_b32 s75, s66, s42
  s_cselect_b32 s70, s67, s68
  s_add_u32 s27, s27, s46
  s_add_u32 s28, s28, s75
  s_add_u32 s29, s29, s70
  s_add_u32 s30, s30, 39424
  s_cmp_eq_u32 s30, 157696
  s_cselect_b32 s30, 0, s30
  v_and_b32 v4, 15, v0
  v_lshrrev_b32 v5, 4, v0
  v_lshrrev_b32 v6, 1, v4
  v_xor_b32 v6, v5, v6
  s_lshl_b32 s32, s41, 5
  v_add_u32 v7, s32, v4
  v_lshlrev_b32 v7, 7, v7
  v_lshl_add_u32 v14, v6, 4, v7
  v_xor_b32 v6, 4, v6
  v_lshl_add_u32 v15, v6, 4, v7
  v_lshrrev_b32 v6, 2, v4
  v_lshl_add_u32 v6, v5, 3, v6
  v_mul_u32_u24 v6, 40, v6
  v_and_b32 v7, 3, v0
  v_lshl_add_u32 v6, v7, 3, v6
  s_and_b32 s32, s23, 1
  s_lshl_b32 s32, s32, 5
  s_add_u32 s32, s32, 36864
  v_add_u32 v36, s32, v6
  v_mov_b32 v28, 0
  v_mov_b32 v29, 0
  v_mov_b32 v30, 0
  v_mov_b32 v31, 0
  v_mov_b32 v32, 0
  v_mov_b32 v33, 0
  v_mov_b32 v34, 0
  v_mov_b32 v35, 0
  s_mov_b32 s47, 0
  s_waitcnt vmcnt(10)
  s_barrier
  v_add_u32 v37, s47, v14
  v_add_u32 v38, s47, v15
  v_add_u32 v39, s47, v36
  ds_read_b128 v[16:19], v37 offset:0
  ds_read_b128 v[20:23], v37 offset:2048
  ds_read_b64_tr_b16 v[24:25], v39 offset:0
  ds_read_b64_tr_b16 v[26:27], v39 offset:160
  ds_read_b128 v[40:43], v38 offset:0
  ds_read_b128 v[44:47], v38 offset:2048
  ds_read_b64_tr_b16 v[48:49], v39 offset:1280
  ds_read_b64_tr_b16 v[50:51], v39 offset:1440
  s_add_u32 m0, s30, s43
  s_nop 0
  buffer_load_dwordx4 v2, s[4:7], s27 offen offset:0 lds
  buffer_load_dwordx4 v63, s[4:7], s27 offen offset:1024 lds
  buffer_load_dwordx4 v64, s[4:7], s27 offen offset:2048 lds
  buffer_load_dwordx4 v65, s[4:7], s27 offen offset:3072 lds
  s_waitcnt lgkmcnt(0)
  s_cmp_lt_u32 s23, 2
  s_cbranch_scc0 L_proj_kernel_exvp
  v_mfma_f32_16x16x32_bf16 v[28:31], v[24:27], v[16:19], v[28:31]
  v_mfma_f32_16x16x32_bf16 v[32:35], v[24:27], v[20:23], v[32:35]
  v_mfma_f32_16x16x32_bf16 v[28:31], v[48:51], v[40:43], v[28:31]
  v_mfma_f32_16x16x32_bf16 v[32:35], v[48:51], v[44:47], v[32:35]
  s_branch L_proj_kernel_exdp
L_proj_kernel_exvp:
  v_mfma_f32_16x16x32_bf16 v[28:31], v[16:19], v[24:27], v[28:31]
  v_mfma_f32_16x16x32_bf16 v[32:35], v[20:23], v[24:27], v[32:35]
  v_mfma_f32_16x16x32_bf16 v[28:31], v[40:43], v[48:51], v[28:31]
  v_mfma_f32_16x16x32_bf16 v[32:35], v[44:47], v[48:51], v[32:35]
L_proj_kernel_exdp:
  s_add_u32 s47, s47, 39424
  s_cmp_eq_u32 s47, 157696
  s_cselect_b32 s47, 0, s47
  s_add_u32 m0, s30, s44
  s_nop 0
  buffer_load_dwordx4 v8, s[8:11], s28 offen offset:0 lds
  buffer_load_dwordx4 v9, s[8:11], s28 offen offset:1024 lds
  buffer_load_dwordx4 v10, s[8:11], s28 offen offset:2048 lds
  buffer_load_dwordx4 v11, s[8:11], s28 offen offset:3072 lds
  s_add_u32 m0, m0, 4096
  s_nop 0
  buffer_load_dwordx4 v12, s[8:11], s28 offen lds
  s_add_u32 m0, s30, s45
  s_mov_b32 exec_hi, 0xff
  buffer_load_dwordx4 v13, s[12:15], s29 offen lds
  s_mov_b64 exec, -1
  s_add_u32 s74, s74, 1
  s_cmp_eq_u32 s74, 10
  s_cselect_b32 s74, 0, s74
  s_cselect_b32 s46, s64, s65
  s_cselect_b32 s75, s66, s42
  s_cselect_b32 s70, s67, s68
  s_add_u32 s27, s27, s46
  s_add_u32 s28, s28, s75
  s_add_u32 s29, s29, s70
  s_add_u32 s30, s30, 39424
  s_cmp_eq_u32 s30, 157696
  s_cselect_b32 s30, 0, s30
  s_mov_b32 s31, 0
L_proj_kernel_aloop:
  s_waitcnt vmcnt(10)
  s_barrier
  v_add_u32 v37, s47, v14
  v_add_u32 v38, s47, v15
  v_add_u32 v39, s47, v36
  ds_read_b128 v[16:19], v37 offset:0
  ds_read_b128 v[20:23], v37 offset:2048
  ds_read_b64_tr_b16 v[24:25], v39 offset:0
  ds_read_b64_tr_b16 v[26:27], v39 offset:160
  ds_read_b128 v[40:43], v38 offset:0
  ds_read_b128 v[44:47], v38 offset:2048
  ds_read_b64_tr_b16 v[48:49], v39 offset:1280
  ds_read_b64_tr_b16 v[50:51], v39 offset:1440
  s_add_u32 m0, s30, s43
  s_nop 0
  buffer_load_dwordx4 v2, s[4:7], s27 offen offset:0 lds
  buffer_load_dwordx4 v63, s[4:7], s27 offen offset:1024 lds
  buffer_load_dwordx4 v64, s[4:7], s27 offen offset:2048 lds
  buffer_load_dwordx4 v65, s[4:7], s27 offen offset:3072 lds
  s_waitcnt lgkmcnt(0)
  s_cmp_lt_u32 s23, 2
  s_cbranch_scc0 L_proj_kernel_exvl
  v_mfma_f32_16x16x32_bf16 v[28:31], v[24:27], v[16:19], v[28:31]
  v_mfma_f32_16x16x32_bf16 v[32:35], v[24:27], v[20:23], v[32:35]
  v_mfma_f32_16x16x32_bf16 v[28:31], v[48:51], v[40:43], v[28:31]
  v_mfma_f32_16x16x32_bf16 v[32:35], v[48:51], v[44:47], v[32:35]
  s_branch L_proj_kernel_exdl
L_proj_kernel_exvl:
  v_mfma_f32_16x16x32_bf16 v[28:31], v[16:19], v[24:27], v[28:31]
  v_mfma_f32_16x16x32_bf16 v[32:35], v[20:23], v[24:27], v[32:35]
  v_mfma_f32_16x16x32_bf16 v[28:31], v[40:43], v[48:51], v[28:31]
  v_mfma_f32_16x16x32_bf16 v[32:35], v[44:47], v[48:51], v[32:35]
L_proj_kernel_exdl:
  s_add_u32 s47, s47, 39424
  s_cmp_eq_u32 s47, 157696
  s_cselect_b32 s47, 0, s47
  s_add_u32 m0, s30, s44
  s_nop 0
  buffer_load_dwordx4 v8, s[8:11], s28 offen offset:0 lds
  buffer_load_dwordx4 v9, s[8:11], s28 offen offset:1024 lds
  buffer_load_dwordx4 v10, s[8:11], s28 offen offset:2048 lds
  buffer_load_dwordx4 v11, s[8:11], s28 offen offset:3072 lds
  s_add_u32 m0, m0, 4096
  s_nop 0
  buffer_load_dwordx4 v12, s[8:11], s28 offen lds
  s_add_u32 m0, s30, s45
  s_mov_b32 exec_hi, 0xff
  buffer_load_dwordx4 v13, s[12:15], s29 offen lds
  s_mov_b64 exec, -1
  s_add_u32 s74, s74, 1
  s_cmp_eq_u32 s74, 10
  s_cselect_b32 s74, 0, s74
  s_cselect_b32 s46, s64, s65
  s_cselect_b32 s75, s66, s42
  s_cselect_b32 s70, s67, s68
  s_add_u32 s27, s27, s46
  s_add_u32 s28, s28, s75
  s_add_u32 s29, s29, s70
  s_add_u32 s30, s30, 39424
  s_cmp_eq_u32 s30, 157696
  s_cselect_b32 s30, 0, s30
  s_add_u32 s31, s31, 1
  s_cmp_lt_u32 s31, 7
  s_cbranch_scc1 L_proj_kernel_aloop
  s_waitcnt vmcnt(10)
  s_barrier
  v_add_u32 v37, s47, v14
  v_add_u32 v38, s47, v15
  v_add_u32 v39, s47, v36
  ds_read_b128 v[16:19], v37 offset:0
  ds_read_b128 v[20:23], v37 offset:2048
  ds_read_b64_tr_b16 v[24:25], v39 offset:0
  ds_read_b64_tr_b16 v[26:27], v39 offset:160
  ds_read_b128 v[40:43], v38 offset:0
  ds_read_b128 v[44:47], v38 offset:2048
  ds_read_b64_tr_b16 v[48:49], v39 offset:1280
  ds_read_b64_tr_b16 v[50:51], v39 offset:1440
  s_waitcnt lgkmcnt(0)
  s_cmp_lt_u32 s23, 2
  s_cbranch_scc0 L_proj_kernel_exv7
  v_mfma_f32_16x16x32_bf16 v[28:31], v[24:27], v[16:19], v[28:31]
  v_mfma_f32_16x16x32_bf16 v[32:35], v[24:27], v[20:23], v[32:35]
  v_mfma_f32_16x16x32_bf16 v[28:31], v[48:51], v[40:43], v[28:31]
  v_mfma_f32_16x16x32_bf16 v[32:35], v[48:51], v[44:47], v[32:35]
  s_branch L_proj_kernel_exd7
L_proj_kernel_exv7:
  v_mfma_f32_16x16x32_bf16 v[28:31], v[16:19], v[24:27], v[28:31]
  v_mfma_f32_16x16x32_bf16 v[32:35], v[20:23], v[24:27], v[32:35]
  v_mfma_f32_16x16x32_bf16 v[28:31], v[40:43], v[48:51], v[28:31]
  v_mfma_f32_16x16x32_bf16 v[32:35], v[44:47], v[48:51], v[32:35]
L_proj_kernel_exd7:
  s_add_u32 s47, s47, 39424
  s_cmp_eq_u32 s47, 157696
  s_cselect_b32 s47, 0, s47
  s_waitcnt vmcnt(0)
  s_barrier
  v_add_u32 v37, s47, v14
  v_add_u32 v38, s47, v15
  v_add_u32 v39, s47, v36
  ds_read_b128 v[16:19], v37 offset:0
  ds_read_b128 v[20:23], v37 offset:2048
  ds_read_b64_tr_b16 v[24:25], v39 offset:0
  ds_read_b64_tr_b16 v[26:27], v39 offset:160
  ds_read_b128 v[40:43], v38 offset:0
  ds_read_b128 v[44:47], v38 offset:2048
  ds_read_b64_tr_b16 v[48:49], v39 offset:1280
  ds_read_b64_tr_b16 v[50:51], v39 offset:1440
  s_waitcnt lgkmcnt(0)
  s_cmp_lt_u32 s23, 2
  s_cbranch_scc0 L_proj_kernel_exv8
  v_mfma_f32_16x16x32_bf16 v[28:31], v[24:27], v[16:19], v[28:31]
  v_mfma_f32_16x16x32_bf16 v[32:35], v[24:27], v[20:23], v[32:35]
  v_mfma_f32_16x16x32_bf16 v[28:31], v[48:51], v[40:43], v[28:31]
  v_mfma_f32_16x16x32_bf16 v[32:35], v[48:51], v[44:47], v[32:35]
  s_branch L_proj_kernel_exd8
L_proj_kernel_exv8:
  v_mfma_f32_16x16x32_bf16 v[28:31], v[16:19], v[24:27], v[28:31]
  v_mfma_f32_16x16x32_bf16 v[32:35], v[20:23], v[24:27], v[32:35]
  v_mfma_f32_16x16x32_bf16 v[28:31], v[40:43], v[48:51], v[28:31]
  v_mfma_f32_16x16x32_bf16 v[32:35], v[44:47], v[48:51], v[32:35]
L_proj_kernel_exd8:
  s_add_u32 s47, s47, 39424
  s_cmp_eq_u32 s47, 157696
  s_cselect_b32 s47, 0, s47
  s_nop 7
  v_cvt_pk_bf16_f32 v40, v28, v29
  v_cvt_pk_bf16_f32 v41, v30, v31
  v_cvt_pk_bf16_f32 v42, v32, v33
  v_cvt_pk_bf16_f32 v43, v34, v35
  s_lshl_b32 s32, s22, 1
  s_lshr_b32 s33, s41, 1
  s_add_u32 s32, s32, s33
  s_mul_i32 s32, s32, 5120
  s_add_u32 s32, s32, 0
  s_add_u32 s16, s24, s32
  s_addc_u32 s17, s25, 0
  s_and_b32 s17, s17, 0xffff
  s_mov_b32 s18, 5120
  s_mov_b32 s19, 0x20000
  s_and_b32 s33, s41, 1
  v_and_b32 v4, 15, v0
  v_lshrrev_b32 v5, 4, v0
  v_lshrrev_b32 v6, 1, v5
  v_and_b32 v7, 1, v5
  s_cmp_lt_u32 s23, 2
  s_cbranch_scc0 L_proj_kernel_stv
  s_cmp_eq_u32 s23, 0
  s_cbranch_scc0 L_proj_kernel_stk2
  s_lshl_b32 s33, s33, 10
  v_lshlrev_b32 v6, 9, v6
  v_lshl_add_u32 v6, v7, 3, v6
  v_lshl_add_u32 v6, v4, 4, v6
  v_add_u32 v6, s33, v6
  buffer_store_dwordx2 v[40:41], v6, s[16:19], 0 offen sc1
  buffer_store_dwordx2 v[42:43], v6, s[16:19], 0 offen offset:256 sc1
  s_endpgm
L_proj_kernel_stk2:
  s_lshl_b32 s33, s33, 8
  s_add_u32 s33, s33, 2048
  v_lshlrev_b32 v6, 3, v4
  v_add_u32 v6, s33, v6
  s_mov_b64 exec, 0xffff
  buffer_store_dwordx2 v[40:41], v6, s[16:19], 0 offen sc1
  buffer_store_dwordx2 v[42:43], v6, s[16:19], 0 offen offset:128 sc1
  s_endpgm
L_proj_kernel_stv:
  s_mul_i32 s33, s33, 1280
  s_add_u32 s33, s33, 2560
  s_and_b32 s34, s23, 1
  s_cmp_eq_u32 s34, 0
  s_cbranch_scc0 L_proj_kernel_stv3
  v_lshlrev_b32 v8, 3, v6
  v_add_u32 v8, v8, v4
  v_and_b32 v8, 15, v8
  v_lshl_add_u32 v8, v6, 4, v8
  v_lshlrev_b32 v8, 4, v8
  v_lshl_add_u32 v6, v7, 3, v8
  v_add_u32 v6, s33, v6
  s_branch L_proj_kernel_stv2
L_proj_kernel_stv3:
  v_lshl_add_u32 v8, v6, 2, v4
  v_lshlrev_b32 v8, 4, v8
  v_lshl_add_u32 v6, v7, 3, v8
  s_add_u32 s33, s33, 512
  v_add_u32 v6, s33, v6
  s_mov_b32 exec_lo, 0x000f000f
  s_mov_b32 exec_hi, 0x000f000f
L_proj_kernel_stv2:
  buffer_store_dwordx2 v[40:41], v6, s[16:19], 0 offen sc1
  buffer_store_dwordx2 v[42:43], v6, s[16:19], 0 offen offset:640 sc1
  s_endpgm
L_proj_kernel_cons:
  s_mul_i32 s32, s20, 50
  v_min_u32 v11, 49, v0
  v_add_u32 v11, s32, v11
  s_mul_i32 s32, s2, 10240
  v_lshlrev_b32 v2, 7, v11
  v_add_u32 v2, s32, v2
  v_subrev_u32 v3, 10240, v2
  s_mul_i32 s33, s2, 40
  s_sub_u32 s33, s33, 160
  v_add_u32 v4, s33, v11
  v_max_i32 v4, 0, v4
  v_mul_u32_u24 v5, 13108, v4
  v_lshrrev_b32 v5, 19, v5
  v_mul_u32_u24 v6, 40, v5
  v_sub_u32 v4, v4, v6
  v_add_u32 v5, 64, v5
  v_mul_u32_u24 v6, 1280, v5
  v_lshl_add_u32 v6, v4, 7, v6
  v_mul_u32_u24 v5, 3840, v5
  v_subrev_u32 v7, 10, v4
  v_lshl_add_u32 v5, v7, 7, v5
  v_cmp_le_u32 vcc, 10, v4
  s_waitcnt lgkmcnt(0)
  v_mov_b32 v7, s50
  v_mov_b32 v8, s51
  v_mov_b32 v9, s58
  v_mov_b32 v10, s59
  v_cndmask_b32 v6, v6, v5, vcc
  v_cndmask_b32 v7, v7, v9, vcc
  v_cndmask_b32 v8, v8, v10, vcc
  v_mov_b32 v9, 327680
  v_mov_b32 v10, 983040
  v_cndmask_b32 v188, v9, v10, vcc
  v_cmp_le_u32 vcc, 80, v11
  v_mov_b32 v4, s48
  v_mov_b32 v5, s49
  v_mov_b32 v9, s56
  v_mov_b32 v10, s57
  v_cndmask_b32 v2, v2, v3, vcc
  v_cndmask_b32 v4, v4, v9, vcc
  v_cndmask_b32 v5, v5, v10, vcc
  v_cmp_le_u32 vcc, 160, v11
  s_nop 1
  v_cndmask_b32 v2, v2, v6, vcc
  v_cndmask_b32 v4, v4, v7, vcc
  v_cndmask_b32 v5, v5, v8, vcc
  v_cndmask_b32 v188, 0, v188, vcc
  v_add_co_u32 v186, vcc, v4, v2
  s_nop 1
  v_addc_co_u32 v187, vcc, 0, v5, vcc
  global_load_dword v191, v[186:187], off
  v_add_co_u32 v186, vcc, v186, v188
  s_nop 1
  v_addc_co_u32 v187, vcc, 0, v187, vcc
  s_cmp_eq_u32 s20, 3
  s_cbranch_scc0 L_proj_kernel_notin
  s_waitcnt lgkmcnt(0)
  v_mov_b32 v2, s48
  v_mov_b32 v3, s49
  s_add_u32 s72, s48, 2097152
  s_addc_u32 s73, s49, 0
  v_writelane_b32 v2, s72, 1
  v_writelane_b32 v3, s73, 1
  s_add_u32 s72, s56, 0
  s_addc_u32 s73, s57, 0
  v_writelane_b32 v2, s72, 2
  v_writelane_b32 v3, s73, 2
  s_add_u32 s72, s56, 2097152
  s_addc_u32 s73, s57, 0
  v_writelane_b32 v2, s72, 3
  v_writelane_b32 v3, s73, 3
  s_add_u32 s72, s50, 0
  s_addc_u32 s73, s51, 0
  v_writelane_b32 v2, s72, 4
  v_writelane_b32 v3, s73, 4
  s_add_u32 s72, s58, 0
  s_addc_u32 s73, s59, 0
  v_writelane_b32 v2, s72, 5
  v_writelane_b32 v3, s73, 5
  s_add_u32 s72, s58, 2097152
  s_addc_u32 s73, s59, 0
  v_writelane_b32 v2, s72, 6
  v_writelane_b32 v3, s73, 6
  s_add_u32 s72, s52, 0
  s_addc_u32 s73, s53, 0
  v_writelane_b32 v2, s72, 7
  v_writelane_b32 v3, s73, 7
  s_add_u32 s72, s54, 0
  s_addc_u32 s73, s55, 0
  v_writelane_b32 v2, s72, 8
  v_writelane_b32 v3, s73, 8
  s_mov_b64 exec, 0x1ff
  global_load_dword v191, v[2:3], off
  s_mov_b64 exec, -1
L_proj_kernel_notin:
  s_lshr_b32 s32, s2, 3
  s_lshl_b32 s32, s32, 3
  s_or_b32 s32, s32, s20
  s_and_b32 s32, s32, 0xffffffff
  s_cmp_eq_u32 s32, 0
  s_cbranch_scc0 L_proj_kernel_nocpf
  s_getpc_b64 s[72:73]
L_pc_proj_kernel:
  s_sub_u32 s72, s72, L_pc_proj_kernel-proj_kernel
  s_subb_u32 s73, s73, 0
  v_lshlrev_b32 v2, 6, v0
  v_min_u32 v3, L_outp_kernel_end-proj_kernel-4, v2
  v_mov_b32 v5, s73
  v_add_co_u32 v4, vcc, s72, v3
  v_add_u32 v2, 4096, v2
  s_nop 0
  v_addc_co_u32 v5, vcc, 0, v5, vcc
  global_load_dword v191, v[4:5], off
  v_min_u32 v3, L_outp_kernel_end-proj_kernel-4, v2
  v_mov_b32 v5, s73
  v_add_co_u32 v4, vcc, s72, v3
  v_add_u32 v2, 4096, v2
  s_nop 0
  v_addc_co_u32 v5, vcc, 0, v5, vcc
  global_load_dword v191, v[4:5], off
  v_min_u32 v3, L_outp_kernel_end-proj_kernel-4, v2
  v_mov_b32 v5, s73
  v_add_co_u32 v4, vcc, s72, v3
  v_add_u32 v2, 4096, v2
  s_nop 0
  v_addc_co_u32 v5, vcc, 0, v5, vcc
  global_load_dword v191, v[4:5], off
  v_min_u32 v3, L_outp_kernel_end-proj_kernel-4, v2
  v_mov_b32 v5, s73
  v_add_co_u32 v4, vcc, s72, v3
  v_add_u32 v2, 4096, v2
  s_nop 0
  v_addc_co_u32 v5, vcc, 0, v5, vcc
  global_load_dword v191, v[4:5], off
  v_min_u32 v3, L_outp_kernel_end-proj_kernel-4, v2
  v_mov_b32 v5, s73
  v_add_co_u32 v4, vcc, s72, v3
  v_add_u32 v2, 4096, v2
  s_nop 0
  v_addc_co_u32 v5, vcc, 0, v5, vcc
  global_load_dword v191, v[4:5], off
  v_min_u32 v3, L_outp_kernel_end-proj_kernel-4, v2
  v_mov_b32 v5, s73
  v_add_co_u32 v4, vcc, s72, v3
  v_add_u32 v2, 4096, v2
  s_nop 0
  v_addc_co_u32 v5, vcc, 0, v5, vcc
  global_load_dword v191, v[4:5], off
  v_min_u32 v3, L_outp_kernel_end-proj_kernel-4, v2
  v_mov_b32 v5, s73
  v_add_co_u32 v4, vcc, s72, v3
  v_add_u32 v2, 4096, v2
  s_nop 0
  v_addc_co_u32 v5, vcc, 0, v5, vcc
  global_load_dword v191, v[4:5], off
  v_min_u32 v3, L_outp_kernel_end-proj_kernel-4, v2
  v_mov_b32 v5, s73
  v_add_co_u32 v4, vcc, s72, v3
  v_add_u32 v2, 4096, v2
  s_nop 0
  v_addc_co_u32 v5, vcc, 0, v5, vcc
  global_load_dword v191, v[4:5], off
  s_load_dwordx2 s[74:75], s[0:1], 64
  s_load_dwordx2 s[76:77], s[0:1], 32
  s_load_dwordx2 s[78:79], s[0:1], 56
  s_waitcnt lgkmcnt(0)
  v_min_u32 v2, 5, v0
  v_lshlrev_b32 v2, 21, v2
  s_mov_b64 exec, 0x3f
  global_load_dword v191, v2, s[24:25]
  s_mov_b64 exec, -1
  v_min_u32 v2, 2, v0
  v_lshlrev_b32 v2, 21, v2
  s_mov_b64 exec, 0x7
  global_load_dword v191, v2, s[74:75]
  s_mov_b64 exec, -1
  v_mov_b32 v2, 0
  s_mov_b64 exec, 1
  global_load_dword v191, v2, s[76:77]
  global_load_dword v191, v2, s[78:79]
  s_mov_b64 exec, -1
L_proj_kernel_nocpf:
  s_lshr_b32 s41, s20, 1
  s_and_b32 s42, s20, 1
  v_and_b32 v4, 15, v0
  v_lshrrev_b32 v5, 4, v0
  v_lshrrev_b32 v6, 1, v4
  v_xor_b32 v6, v5, v6
  s_lshl_b32 s32, s41, 6
  v_add_u32 v7, s32, v4
  v_lshlrev_b32 v7, 7, v7
  v_lshl_add_u32 v168, v6, 4, v7
  v_xor_b32 v6, 4, v6
  v_lshl_add_u32 v169, v6, 4, v7
  v_add_u32 v170, 78848, v168
  v_add_u32 v171, 78848, v169
  v_lshrrev_b32 v6, 2, v4
  v_lshl_add_u32 v6, v5, 3, v6
  v_mul_u32_u24 v6, 320, v6
  v_add_u32 v6, 16384, v6
  v_and_b32 v7, 3, v0
  v_and_b32 v8, 1, v5
  v_lshlrev_b32 v8, 5, v8
  s_mul_i32 s32, s42, 160
  v_add_u32 v8, s32, v8
  v_lshl_add_u32 v9, v7, 3, v8
  v_mul_u32_u24 v10, 40, v7
  v_add3_u32 v10, v10, v8, 32
  v_mov_b32 v11, v9
  v_cmp_le_u32 vcc, 320, v11
  v_subrev_u32 v12, 320, v11
  s_nop 0
  v_cndmask_b32 v11, v11, v12, vcc
  v_add_u32 v172, v11, v6
  v_add_u32 v177, 78848, v172
  v_add_u32 v11, 40, v9
  v_cmp_le_u32 vcc, 320, v11
  v_subrev_u32 v12, 320, v11
  s_nop 0
  v_cndmask_b32 v11, v11, v12, vcc
  v_add_u32 v173, v11, v6
  v_add_u32 v178, 78848, v173
  v_add_u32 v11, 80, v9
  v_cmp_le_u32 vcc, 320, v11
  v_subrev_u32 v12, 320, v11
  s_nop 0
  v_cndmask_b32 v11, v11, v12, vcc
  v_add_u32 v174, v11, v6
  v_add_u32 v179, 78848, v174
  v_add_u32 v11, 120, v9
  v_cmp_le_u32 vcc, 320, v11
  v_subrev_u32 v12, 320, v11
  s_nop 0
  v_cndmask_b32 v11, v11, v12, vcc
  v_add_u32 v175, v11, v6
  v_add_u32 v180, 78848, v175
  v_mov_b32 v11, v10
  v_cmp_le_u32 vcc, 320, v11
  v_subrev_u32 v12, 320, v11
  s_nop 0
  v_cndmask_b32 v11, v11, v12, vcc
  v_add_u32 v176, v11, v6
  v_add_u32 v181, 78848, v176
  s_cmp_le_u32 s21, 1
  s_mov_b32 s43, 163840
  s_cselect_b32 s43, 81920, s43
  s_lshl_b32 s44, s42, 2
  s_mul_i32 s44, s44, s43
  s_cmp_eq_u32 s21, 3
  s_cbranch_scc1 L_proj_kernel_adV
  v_lshlrev_b32 v182, 4, v0
  v_mul_u32_u24 v6, s43, v5
  v_lshl_add_u32 v183, v4, 3, v6
  s_branch L_proj_kernel_adD
L_proj_kernel_adV:
  v_and_b32 v6, 1, v5
  v_mul_u32_u24 v6, 640, v6
  v_lshrrev_b32 v7, 1, v5
  v_lshlrev_b32 v8, 3, v7
  v_add_u32 v8, v8, v4
  v_and_b32 v8, 15, v8
  v_lshl_add_u32 v8, v7, 4, v8
  v_lshl_add_u32 v182, v8, 4, v6
  v_and_b32 v8, 3, v4
  v_lshl_add_u32 v8, v7, 2, v8
  v_lshl_add_u32 v6, v8, 4, v6
  v_add_u32 v6, 512, v6
  v_lshrrev_b32 v7, 2, v4
  v_mul_u32_u24 v7, s43, v7
  v_add_u32 v183, v6, v7
L_proj_kernel_adD:
  s_waitcnt lgkmcnt(0)
  s_cmp_le_u32 s21, 1
  s_cbranch_scc0 L_proj_kernel_osK
  s_lshl_b32 s32, s21, 5
  s_lshl_b32 s33, s23, 3
  s_add_u32 s32, s32, s33
  s_mul_i32 s32, s32, 81920
  s_lshl_b32 s33, s22, 2
  s_lshl_b32 s34, s41, 1
  s_add_u32 s33, s33, s34
  s_mul_i32 s33, s33, 1280
  s_add_u32 s32, s32, s33
  s_add_u32 s32, s32, 5406720
  s_branch L_proj_kernel_osD
L_proj_kernel_osK:
  s_lshl_b32 s32, s23, 3
  s_add_u32 s32, s32, 1
  s_mul_i32 s32, s32, 163840
  s_lshl_b32 s33, s22, 1
  s_add_u32 s33, s33, s41
  s_mul_i32 s33, s33, 5120
  s_add_u32 s32, s32, s33
  s_cmp_eq_u32 s21, 3
  s_cselect_b32 s33, 2560, 0
  s_add_u32 s32, s32, s33
  s_add_u32 s32, s32, 0
L_proj_kernel_osD:
  s_add_u32 s16, s24, s32
  s_addc_u32 s17, s25, 0
  s_and_b32 s17, s17, 0xffff
  s_mov_b32 s18, 1310720
  s_mov_b32 s19, 0x20000
  s_barrier
  s_cmp_eq_u32 s20, 3
  s_cselect_b32 s32, -1, 0
  s_and_b32 exec_lo, s32, 0xfffffc00
  s_and_b32 exec_hi, s32, 0x3ffff
  s_cbranch_execz L_proj_kernel_nolate
  global_load_dword v191, v[186:187], off
L_proj_kernel_nolate:
  s_mov_b64 exec, -1
  ds_read_b128 v[96:99], v168 offset:0
  ds_read_b64_tr_b16 v[128:129], v172 offset:0
  ds_read_b64_tr_b16 v[130:131], v172 offset:1280
  ds_read_b128 v[100:103], v168 offset:2048
  ds_read_b64_tr_b16 v[132:133], v173 offset:0
  ds_read_b64_tr_b16 v[134:135], v173 offset:1280
  ds_read_b128 v[104:107], v168 offset:4096
  ds_read_b64_tr_b16 v[136:137], v174 offset:0
  ds_read_b64_tr_b16 v[138:139], v174 offset:1280
  ds_read_b128 v[108:111], v168 offset:6144
  ds_read_b64_tr_b16 v[140:141], v175 offset:0
  ds_read_b64_tr_b16 v[142:143], v175 offset:1280
  ds_read_b64_tr_b16 v[144:145], v176 offset:0
  ds_read_b64_tr_b16 v[146:147], v176 offset:1280
  s_cmp_eq_u32 s21, 3
  s_cbranch_scc1 L_proj_kernel_consV
  s_waitcnt lgkmcnt(0)
  v_mfma_f32_16x16x32_bf16 v[16:19], v[128:131], v[96:99], 0
  ds_read_b128 v[112:115], v169 offset:0
  v_mfma_f32_16x16x32_bf16 v[36:39], v[128:131], v[100:103], 0
  ds_read_b64_tr_b16 v[148:149], v172 offset:10240
  v_mfma_f32_16x16x32_bf16 v[56:59], v[128:131], v[104:107], 0
  ds_read_b64_tr_b16 v[150:151], v172 offset:11520
  v_mfma_f32_16x16x32_bf16 v[76:79], v[128:131], v[108:111], 0
  ds_read_b128 v[116:119], v169 offset:2048
  v_mfma_f32_16x16x32_bf16 v[20:23], v[132:135], v[96:99], 0
  ds_read_b64_tr_b16 v[152:153], v173 offset:10240
  v_mfma_f32_16x16x32_bf16 v[40:43], v[132:135], v[100:103], 0
  ds_read_b64_tr_b16 v[154:155], v173 offset:11520
  v_mfma_f32_16x16x32_bf16 v[60:63], v[132:135], v[104:107], 0
  ds_read_b128 v[120:123], v169 offset:4096
  v_mfma_f32_16x16x32_bf16 v[80:83], v[132:135], v[108:111], 0
  ds_read_b64_tr_b16 v[156:157], v174 offset:10240
  v_mfma_f32_16x16x32_bf16 v[24:27], v[136:139], v[96:99], 0
  ds_read_b64_tr_b16 v[158:159], v174 offset:11520
  v_mfma_f32_16x16x32_bf16 v[44:47], v[136:139], v[100:103], 0
  ds_read_b128 v[124:127], v169 offset:6144
  v_mfma_f32_16x16x32_bf16 v[64:67], v[136:139], v[104:107], 0
  ds_read_b64_tr_b16 v[160:161], v175 offset:10240
  v_mfma_f32_16x16x32_bf16 v[84:87], v[136:139], v[108:111], 0
  ds_read_b64_tr_b16 v[162:163], v175 offset:11520
  v_mfma_f32_16x16x32_bf16 v[28:31], v[140:143], v[96:99], 0
  ds_read_b64_tr_b16 v[164:165], v176 offset:10240
  v_mfma_f32_16x16x32_bf16 v[48:51], v[140:143], v[100:103], 0
  ds_read_b64_tr_b16 v[166:167], v176 offset:11520
  v_mfma_f32_16x16x32_bf16 v[68:71], v[140:143], v[104:107], 0
  v_mfma_f32_16x16x32_bf16 v[88:91], v[140:143], v[108:111], 0
  v_mfma_f32_16x16x32_bf16 v[32:35], v[144:147], v[96:99], 0
  v_mfma_f32_16x16x32_bf16 v[52:55], v[144:147], v[100:103], 0
  v_mfma_f32_16x16x32_bf16 v[72:75], v[144:147], v[104:107], 0
  v_mfma_f32_16x16x32_bf16 v[92:95], v[144:147], v[108:111], 0
  s_waitcnt lgkmcnt(0)
  s_barrier
  v_mfma_f32_16x16x32_bf16 v[16:19], v[148:151], v[112:115], v[16:19]
  ds_read_b128 v[96:99], v168 offset:39424
  v_mfma_f32_16x16x32_bf16 v[36:39], v[148:151], v[116:119], v[36:39]
  ds_read_b64_tr_b16 v[128:129], v172 offset:39424
  v_mfma_f32_16x16x32_bf16 v[56:59], v[148:151], v[120:123], v[56:59]
  ds_read_b64_tr_b16 v[130:131], v172 offset:40704
  v_mfma_f32_16x16x32_bf16 v[76:79], v[148:151], v[124:127], v[76:79]
  ds_read_b128 v[100:103], v168 offset:41472
  v_mfma_f32_16x16x32_bf16 v[20:23], v[152:155], v[112:115], v[20:23]
  ds_read_b64_tr_b16 v[132:133], v173 offset:39424
  v_mfma_f32_16x16x32_bf16 v[40:43], v[152:155], v[116:119], v[40:43]
  ds_read_b64_tr_b16 v[134:135], v173 offset:40704
  v_mfma_f32_16x16x32_bf16 v[60:63], v[152:155], v[120:123], v[60:63]
  ds_read_b128 v[104:107], v168 offset:43520
  v_mfma_f32_16x16x32_bf16 v[80:83], v[152:155], v[124:127], v[80:83]
  ds_read_b64_tr_b16 v[136:137], v174 offset:39424
  v_mfma_f32_16x16x32_bf16 v[24:27], v[156:159], v[112:115], v[24:27]
  ds_read_b64_tr_b16 v[138:139], v174 offset:40704
  v_mfma_f32_16x16x32_bf16 v[44:47], v[156:159], v[116:119], v[44:47]
  ds_read_b128 v[108:111], v168 offset:45568
  v_mfma_f32_16x16x32_bf16 v[64:67], v[156:159], v[120:123], v[64:67]
  ds_read_b64_tr_b16 v[140:141], v175 offset:39424
  v_mfma_f32_16x16x32_bf16 v[84:87], v[156:159], v[124:127], v[84:87]
  ds_read_b64_tr_b16 v[142:143], v175 offset:40704
  v_mfma_f32_16x16x32_bf16 v[28:31], v[160:163], v[112:115], v[28:31]
  ds_read_b64_tr_b16 v[144:145], v176 offset:39424
  v_mfma_f32_16x16x32_bf16 v[48:51], v[160:163], v[116:119], v[48:51]
  ds_read_b64_tr_b16 v[146:147], v176 offset:40704
  v_mfma_f32_16x16x32_bf16 v[68:71], v[160:163], v[120:123], v[68:71]
  v_mfma_f32_16x16x32_bf16 v[88:91], v[160:163], v[124:127], v[88:91]
  v_mfma_f32_16x16x32_bf16 v[32:35], v[164:167], v[112:115], v[32:35]
  v_mfma_f32_16x16x32_bf16 v[52:55], v[164:167], v[116:119], v[52:55]
  v_mfma_f32_16x16x32_bf16 v[72:75], v[164:167], v[120:123], v[72:75]
  v_mfma_f32_16x16x32_bf16 v[92:95], v[164:167], v[124:127], v[92:95]
  s_waitcnt lgkmcnt(0)
  v_mfma_f32_16x16x32_bf16 v[16:19], v[128:131], v[96:99], v[16:19]
  ds_read_b128 v[112:115], v169 offset:39424
  v_mfma_f32_16x16x32_bf16 v[36:39], v[128:131], v[100:103], v[36:39]
  ds_read_b64_tr_b16 v[148:149], v172 offset:49664
  v_mfma_f32_16x16x32_bf16 v[56:59], v[128:131], v[104:107], v[56:59]
  ds_read_b64_tr_b16 v[150:151], v172 offset:50944
  v_mfma_f32_16x16x32_bf16 v[76:79], v[128:131], v[108:111], v[76:79]
  ds_read_b128 v[116:119], v169 offset:41472
  v_mfma_f32_16x16x32_bf16 v[20:23], v[132:135], v[96:99], v[20:23]
  ds_read_b64_tr_b16 v[152:153], v173 offset:49664
  v_mfma_f32_16x16x32_bf16 v[40:43], v[132:135], v[100:103], v[40:43]
  ds_read_b64_tr_b16 v[154:155], v173 offset:50944
  v_mfma_f32_16x16x32_bf16 v[60:63], v[132:135], v[104:107], v[60:63]
  ds_read_b128 v[120:123], v169 offset:43520
  v_mfma_f32_16x16x32_bf16 v[80:83], v[132:135], v[108:111], v[80:83]
  ds_read_b64_tr_b16 v[156:157], v174 offset:49664
  v_mfma_f32_16x16x32_bf16 v[24:27], v[136:139], v[96:99], v[24:27]
  ds_read_b64_tr_b16 v[158:159], v174 offset:50944
  v_mfma_f32_16x16x32_bf16 v[44:47], v[136:139], v[100:103], v[44:47]
  ds_read_b128 v[124:127], v169 offset:45568
  v_mfma_f32_16x16x32_bf16 v[64:67], v[136:139], v[104:107], v[64:67]
  ds_read_b64_tr_b16 v[160:161], v175 offset:49664
  v_mfma_f32_16x16x32_bf16 v[84:87], v[136:139], v[108:111], v[84:87]
  ds_read_b64_tr_b16 v[162:163], v175 offset:50944
  v_mfma_f32_16x16x32_bf16 v[28:31], v[140:143], v[96:99], v[28:31]
  ds_read_b64_tr_b16 v[164:165], v176 offset:49664
  v_mfma_f32_16x16x32_bf16 v[48:51], v[140:143], v[100:103], v[48:51]
  ds_read_b64_tr_b16 v[166:167], v176 offset:50944
  v_mfma_f32_16x16x32_bf16 v[68:71], v[140:143], v[104:107], v[68:71]
  v_mfma_f32_16x16x32_bf16 v[88:91], v[140:143], v[108:111], v[88:91]
  v_mfma_f32_16x16x32_bf16 v[32:35], v[144:147], v[96:99], v[32:35]
  v_mfma_f32_16x16x32_bf16 v[52:55], v[144:147], v[100:103], v[52:55]
  v_mfma_f32_16x16x32_bf16 v[72:75], v[144:147], v[104:107], v[72:75]
  v_mfma_f32_16x16x32_bf16 v[92:95], v[144:147], v[108:111], v[92:95]
  s_waitcnt lgkmcnt(0)
  s_barrier
  v_mfma_f32_16x16x32_bf16 v[16:19], v[148:151], v[112:115], v[16:19]
  ds_read_b128 v[96:99], v170 offset:0
  v_mfma_f32_16x16x32_bf16 v[36:39], v[148:151], v[116:119], v[36:39]
  ds_read_b64_tr_b16 v[128:129], v177 offset:0
  v_mfma_f32_16x16x32_bf16 v[56:59], v[148:151], v[120:123], v[56:59]
  ds_read_b64_tr_b16 v[130:131], v177 offset:1280
  v_mfma_f32_16x16x32_bf16 v[76:79], v[148:151], v[124:127], v[76:79]
  ds_read_b128 v[100:103], v170 offset:2048
  v_mfma_f32_16x16x32_bf16 v[20:23], v[152:155], v[112:115], v[20:23]
  ds_read_b64_tr_b16 v[132:133], v178 offset:0
  v_mfma_f32_16x16x32_bf16 v[40:43], v[152:155], v[116:119], v[40:43]
  ds_read_b64_tr_b16 v[134:135], v178 offset:1280
  v_mfma_f32_16x16x32_bf16 v[60:63], v[152:155], v[120:123], v[60:63]
  ds_read_b128 v[104:107], v170 offset:4096
  v_mfma_f32_16x16x32_bf16 v[80:83], v[152:155], v[124:127], v[80:83]
  ds_read_b64_tr_b16 v[136:137], v179 offset:0
  v_mfma_f32_16x16x32_bf16 v[24:27], v[156:159], v[112:115], v[24:27]
  ds_read_b64_tr_b16 v[138:139], v179 offset:1280
  v_mfma_f32_16x16x32_bf16 v[44:47], v[156:159], v[116:119], v[44:47]
  ds_read_b128 v[108:111], v170 offset:6144
  v_mfma_f32_16x16x32_bf16 v[64:67], v[156:159], v[120:123], v[64:67]
  ds_read_b64_tr_b16 v[140:141], v180 offset:0
  v_mfma_f32_16x16x32_bf16 v[84:87], v[156:159], v[124:127], v[84:87]
  ds_read_b64_tr_b16 v[142:143], v180 offset:1280
  v_mfma_f32_16x16x32_bf16 v[28:31], v[160:163], v[112:115], v[28:31]
  ds_read_b64_tr_b16 v[144:145], v181 offset:0
  v_mfma_f32_16x16x32_bf16 v[48:51], v[160:163], v[116:119], v[48:51]
  ds_read_b64_tr_b16 v[146:147], v181 offset:1280
  v_mfma_f32_16x16x32_bf16 v[68:71], v[160:163], v[120:123], v[68:71]
  v_mfma_f32_16x16x32_bf16 v[88:91], v[160:163], v[124:127], v[88:91]
  v_mfma_f32_16x16x32_bf16 v[32:35], v[164:167], v[112:115], v[32:35]
  v_mfma_f32_16x16x32_bf16 v[52:55], v[164:167], v[116:119], v[52:55]
  v_mfma_f32_16x16x32_bf16 v[72:75], v[164:167], v[120:123], v[72:75]
  v_mfma_f32_16x16x32_bf16 v[92:95], v[164:167], v[124:127], v[92:95]
  s_waitcnt lgkmcnt(0)
  v_mfma_f32_16x16x32_bf16 v[16:19], v[128:131], v[96:99], v[16:19]
  ds_read_b128 v[112:115], v171 offset:0
  v_mfma_f32_16x16x32_bf16 v[36:39], v[128:131], v[100:103], v[36:39]
  ds_read_b64_tr_b16 v[148:149], v177 offset:10240
  v_mfma_f32_16x16x32_bf16 v[56:59], v[128:131], v[104:107], v[56:59]
  ds_read_b64_tr_b16 v[150:151], v177 offset:11520
  v_mfma_f32_16x16x32_bf16 v[76:79], v[128:131], v[108:111], v[76:79]
  ds_read_b128 v[116:119], v171 offset:2048
  v_mfma_f32_16x16x32_bf16 v[20:23], v[132:135], v[96:99], v[20:23]
  ds_read_b64_tr_b16 v[152:153], v178 offset:10240
  v_mfma_f32_16x16x32_bf16 v[40:43], v[132:135], v[100:103], v[40:43]
  ds_read_b64_tr_b16 v[154:155], v178 offset:11520
  v_mfma_f32_16x16x32_bf16 v[60:63], v[132:135], v[104:107], v[60:63]
  ds_read_b128 v[120:123], v171 offset:4096
  v_mfma_f32_16x16x32_bf16 v[80:83], v[132:135], v[108:111], v[80:83]
  ds_read_b64_tr_b16 v[156:157], v179 offset:10240
  v_mfma_f32_16x16x32_bf16 v[24:27], v[136:139], v[96:99], v[24:27]
  ds_read_b64_tr_b16 v[158:159], v179 offset:11520
  v_mfma_f32_16x16x32_bf16 v[44:47], v[136:139], v[100:103], v[44:47]
  ds_read_b128 v[124:127], v171 offset:6144
  v_mfma_f32_16x16x32_bf16 v[64:67], v[136:139], v[104:107], v[64:67]
  ds_read_b64_tr_b16 v[160:161], v180 offset:10240
  v_mfma_f32_16x16x32_bf16 v[84:87], v[136:139], v[108:111], v[84:87]
  ds_read_b64_tr_b16 v[162:163], v180 offset:11520
  v_mfma_f32_16x16x32_bf16 v[28:31], v[140:143], v[96:99], v[28:31]
  ds_read_b64_tr_b16 v[164:165], v181 offset:10240
  v_mfma_f32_16x16x32_bf16 v[48:51], v[140:143], v[100:103], v[48:51]
  ds_read_b64_tr_b16 v[166:167], v181 offset:11520
  v_mfma_f32_16x16x32_bf16 v[68:71], v[140:143], v[104:107], v[68:71]
  v_mfma_f32_16x16x32_bf16 v[88:91], v[140:143], v[108:111], v[88:91]
  v_mfma_f32_16x16x32_bf16 v[32:35], v[144:147], v[96:99], v[32:35]
  v_mfma_f32_16x16x32_bf16 v[52:55], v[144:147], v[100:103], v[52:55]
  v_mfma_f32_16x16x32_bf16 v[72:75], v[144:147], v[104:107], v[72:75]
  v_mfma_f32_16x16x32_bf16 v[92:95], v[144:147], v[108:111], v[92:95]
  s_waitcnt lgkmcnt(0)
  s_barrier
  v_mfma_f32_16x16x32_bf16 v[16:19], v[148:151], v[112:115], v[16:19]
  ds_read_b128 v[96:99], v170 offset:39424
  v_mfma_f32_16x16x32_bf16 v[36:39], v[148:151], v[116:119], v[36:39]
  ds_read_b64_tr_b16 v[128:129], v177 offset:39424
  v_mfma_f32_16x16x32_bf16 v[56:59], v[148:151], v[120:123], v[56:59]
  ds_read_b64_tr_b16 v[130:131], v177 offset:40704
  v_mfma_f32_16x16x32_bf16 v[76:79], v[148:151], v[124:127], v[76:79]
  ds_read_b128 v[100:103], v170 offset:41472
  v_mfma_f32_16x16x32_bf16 v[20:23], v[152:155], v[112:115], v[20:23]
  ds_read_b64_tr_b16 v[132:133], v178 offset:39424
  v_mfma_f32_16x16x32_bf16 v[40:43], v[152:155], v[116:119], v[40:43]
  ds_read_b64_tr_b16 v[134:135], v178 offset:40704
  v_mfma_f32_16x16x32_bf16 v[60:63], v[152:155], v[120:123], v[60:63]
  ds_read_b128 v[104:107], v170 offset:43520
  v_mfma_f32_16x16x32_bf16 v[80:83], v[152:155], v[124:127], v[80:83]
  ds_read_b64_tr_b16 v[136:137], v179 offset:39424
  v_mfma_f32_16x16x32_bf16 v[24:27], v[156:159], v[112:115], v[24:27]
  ds_read_b64_tr_b16 v[138:139], v179 offset:40704
  v_mfma_f32_16x16x32_bf16 v[44:47], v[156:159], v[116:119], v[44:47]
  ds_read_b128 v[108:111], v170 offset:45568
  v_mfma_f32_16x16x32_bf16 v[64:67], v[156:159], v[120:123], v[64:67]
  ds_read_b64_tr_b16 v[140:141], v180 offset:39424
  v_mfma_f32_16x16x32_bf16 v[84:87], v[156:159], v[124:127], v[84:87]
  ds_read_b64_tr_b16 v[142:143], v180 offset:40704
  v_mfma_f32_16x16x32_bf16 v[28:31], v[160:163], v[112:115], v[28:31]
  ds_read_b64_tr_b16 v[144:145], v181 offset:39424
  v_mfma_f32_16x16x32_bf16 v[48:51], v[160:163], v[116:119], v[48:51]
  ds_read_b64_tr_b16 v[146:147], v181 offset:40704
  v_mfma_f32_16x16x32_bf16 v[68:71], v[160:163], v[120:123], v[68:71]
  v_mfma_f32_16x16x32_bf16 v[88:91], v[160:163], v[124:127], v[88:91]
  v_mfma_f32_16x16x32_bf16 v[32:35], v[164:167], v[112:115], v[32:35]
  v_mfma_f32_16x16x32_bf16 v[52:55], v[164:167], v[116:119], v[52:55]
  v_mfma_f32_16x16x32_bf16 v[72:75], v[164:167], v[120:123], v[72:75]
  v_mfma_f32_16x16x32_bf16 v[92:95], v[164:167], v[124:127], v[92:95]
  s_waitcnt lgkmcnt(0)
  v_mfma_f32_16x16x32_bf16 v[16:19], v[128:131], v[96:99], v[16:19]
  ds_read_b128 v[112:115], v171 offset:39424
  v_mfma_f32_16x16x32_bf16 v[36:39], v[128:131], v[100:103], v[36:39]
  ds_read_b64_tr_b16 v[148:149], v177 offset:49664
  v_mfma_f32_16x16x32_bf16 v[56:59], v[128:131], v[104:107], v[56:59]
  ds_read_b64_tr_b16 v[150:151], v177 offset:50944
  v_mfma_f32_16x16x32_bf16 v[76:79], v[128:131], v[108:111], v[76:79]
  ds_read_b128 v[116:119], v171 offset:41472
  v_mfma_f32_16x16x32_bf16 v[20:23], v[132:135], v[96:99], v[20:23]
  ds_read_b64_tr_b16 v[152:153], v178 offset:49664
  v_mfma_f32_16x16x32_bf16 v[40:43], v[132:135], v[100:103], v[40:43]
  ds_read_b64_tr_b16 v[154:155], v178 offset:50944
  v_mfma_f32_16x16x32_bf16 v[60:63], v[132:135], v[104:107], v[60:63]
  ds_read_b128 v[120:123], v171 offset:43520
  v_mfma_f32_16x16x32_bf16 v[80:83], v[132:135], v[108:111], v[80:83]
  ds_read_b64_tr_b16 v[156:157], v179 offset:49664
  v_mfma_f32_16x16x32_bf16 v[24:27], v[136:139], v[96:99], v[24:27]
  ds_read_b64_tr_b16 v[158:159], v179 offset:50944
  v_mfma_f32_16x16x32_bf16 v[44:47], v[136:139], v[100:103], v[44:47]
  ds_read_b128 v[124:127], v171 offset:45568
  v_mfma_f32_16x16x32_bf16 v[64:67], v[136:139], v[104:107], v[64:67]
  ds_read_b64_tr_b16 v[160:161], v180 offset:49664
  v_mfma_f32_16x16x32_bf16 v[84:87], v[136:139], v[108:111], v[84:87]
  ds_read_b64_tr_b16 v[162:163], v180 offset:50944
  v_mfma_f32_16x16x32_bf16 v[28:31], v[140:143], v[96:99], v[28:31]
  ds_read_b64_tr_b16 v[164:165], v181 offset:49664
  v_mfma_f32_16x16x32_bf16 v[48:51], v[140:143], v[100:103], v[48:51]
  ds_read_b64_tr_b16 v[166:167], v181 offset:50944
  v_mfma_f32_16x16x32_bf16 v[68:71], v[140:143], v[104:107], v[68:71]
  v_mfma_f32_16x16x32_bf16 v[88:91], v[140:143], v[108:111], v[88:91]
  v_mfma_f32_16x16x32_bf16 v[32:35], v[144:147], v[96:99], v[32:35]
  v_mfma_f32_16x16x32_bf16 v[52:55], v[144:147], v[100:103], v[52:55]
  v_mfma_f32_16x16x32_bf16 v[72:75], v[144:147], v[104:107], v[72:75]
  v_mfma_f32_16x16x32_bf16 v[92:95], v[144:147], v[108:111], v[92:95]
  s_waitcnt lgkmcnt(0)
  s_barrier
  v_mfma_f32_16x16x32_bf16 v[16:19], v[148:151], v[112:115], v[16:19]
  ds_read_b128 v[96:99], v168 offset:0
  v_mfma_f32_16x16x32_bf16 v[36:39], v[148:151], v[116:119], v[36:39]
  ds_read_b64_tr_b16 v[128:129], v172 offset:0
  v_mfma_f32_16x16x32_bf16 v[56:59], v[148:151], v[120:123], v[56:59]
  ds_read_b64_tr_b16 v[130:131], v172 offset:1280
  v_mfma_f32_16x16x32_bf16 v[76:79], v[148:151], v[124:127], v[76:79]
  ds_read_b128 v[100:103], v168 offset:2048
  v_mfma_f32_16x16x32_bf16 v[20:23], v[152:155], v[112:115], v[20:23]
  ds_read_b64_tr_b16 v[132:133], v173 offset:0
  v_mfma_f32_16x16x32_bf16 v[40:43], v[152:155], v[116:119], v[40:43]
  ds_read_b64_tr_b16 v[134:135], v173 offset:1280
  v_mfma_f32_16x16x32_bf16 v[60:63], v[152:155], v[120:123], v[60:63]
  ds_read_b128 v[104:107], v168 offset:4096
  v_mfma_f32_16x16x32_bf16 v[80:83], v[152:155], v[124:127], v[80:83]
  ds_read_b64_tr_b16 v[136:137], v174 offset:0
  v_mfma_f32_16x16x32_bf16 v[24:27], v[156:159], v[112:115], v[24:27]
  ds_read_b64_tr_b16 v[138:139], v174 offset:1280
  v_mfma_f32_16x16x32_bf16 v[44:47], v[156:159], v[116:119], v[44:47]
  ds_read_b128 v[108:111], v168 offset:6144
  v_mfma_f32_16x16x32_bf16 v[64:67], v[156:159], v[120:123], v[64:67]
  ds_read_b64_tr_b16 v[140:141], v175 offset:0
  v_mfma_f32_16x16x32_bf16 v[84:87], v[156:159], v[124:127], v[84:87]
  ds_read_b64_tr_b16 v[142:143], v175 offset:1280
  v_mfma_f32_16x16x32_bf16 v[28:31], v[160:163], v[112:115], v[28:31]
  ds_read_b64_tr_b16 v[144:145], v176 offset:0
  v_mfma_f32_16x16x32_bf16 v[48:51], v[160:163], v[116:119], v[48:51]
  ds_read_b64_tr_b16 v[146:147], v176 offset:1280
  v_mfma_f32_16x16x32_bf16 v[68:71], v[160:163], v[120:123], v[68:71]
  v_mfma_f32_16x16x32_bf16 v[88:91], v[160:163], v[124:127], v[88:91]
  v_mfma_f32_16x16x32_bf16 v[32:35], v[164:167], v[112:115], v[32:35]
  v_mfma_f32_16x16x32_bf16 v[52:55], v[164:167], v[116:119], v[52:55]
  v_mfma_f32_16x16x32_bf16 v[72:75], v[164:167], v[120:123], v[72:75]
  v_mfma_f32_16x16x32_bf16 v[92:95], v[164:167], v[124:127], v[92:95]
  s_waitcnt lgkmcnt(0)
  v_mfma_f32_16x16x32_bf16 v[16:19], v[128:131], v[96:99], v[16:19]
  ds_read_b128 v[112:115], v169 offset:0
  v_mfma_f32_16x16x32_bf16 v[36:39], v[128:131], v[100:103], v[36:39]
  ds_read_b64_tr_b16 v[148:149], v172 offset:10240
  v_mfma_f32_16x16x32_bf16 v[56:59], v[128:131], v[104:107], v[56:59]
  ds_read_b64_tr_b16 v[150:151], v172 offset:11520
  v_mfma_f32_16x16x32_bf16 v[76:79], v[128:131], v[108:111], v[76:79]
  ds_read_b128 v[116:119], v169 offset:2048
  v_mfma_f32_16x16x32_bf16 v[20:23], v[132:135], v[96:99], v[20:23]
  ds_read_b64_tr_b16 v[152:153], v173 offset:10240
  v_mfma_f32_16x16x32_bf16 v[40:43], v[132:135], v[100:103], v[40:43]
  ds_read_b64_tr_b16 v[154:155], v173 offset:11520
  v_mfma_f32_16x16x32_bf16 v[60:63], v[132:135], v[104:107], v[60:63]
  ds_read_b128 v[120:123], v169 offset:4096
  v_mfma_f32_16x16x32_bf16 v[80:83], v[132:135], v[108:111], v[80:83]
  ds_read_b64_tr_b16 v[156:157], v174 offset:10240
  v_mfma_f32_16x16x32_bf16 v[24:27], v[136:139], v[96:99], v[24:27]
  ds_read_b64_tr_b16 v[158:159], v174 offset:11520
  v_mfma_f32_16x16x32_bf16 v[44:47], v[136:139], v[100:103], v[44:47]
  ds_read_b128 v[124:127], v169 offset:6144
  v_mfma_f32_16x16x32_bf16 v[64:67], v[136:139], v[104:107], v[64:67]
  ds_read_b64_tr_b16 v[160:161], v175 offset:10240
  v_mfma_f32_16x16x32_bf16 v[84:87], v[136:139], v[108:111], v[84:87]
  ds_read_b64_tr_b16 v[162:163], v175 offset:11520
  v_mfma_f32_16x16x32_bf16 v[28:31], v[140:143], v[96:99], v[28:31]
  ds_read_b64_tr_b16 v[164:165], v176 offset:10240
  v_mfma_f32_16x16x32_bf16 v[48:51], v[140:143], v[100:103], v[48:51]
  ds_read_b64_tr_b16 v[166:167], v176 offset:11520
  v_mfma_f32_16x16x32_bf16 v[68:71], v[140:143], v[104:107], v[68:71]
  v_mfma_f32_16x16x32_bf16 v[88:91], v[140:143], v[108:111], v[88:91]
  v_mfma_f32_16x16x32_bf16 v[32:35], v[144:147], v[96:99], v[32:35]
  v_mfma_f32_16x16x32_bf16 v[52:55], v[144:147], v[100:103], v[52:55]
  v_mfma_f32_16x16x32_bf16 v[72:75], v[144:147], v[104:107], v[72:75]
  v_mfma_f32_16x16x32_bf16 v[92:95], v[144:147], v[108:111], v[92:95]
  s_waitcnt lgkmcnt(0)
  s_barrier
  v_mfma_f32_16x16x32_bf16 v[16:19], v[148:151], v[112:115], v[16:19]
  ds_read_b128 v[96:99], v168 offset:39424
  v_mfma_f32_16x16x32_bf16 v[36:39], v[148:151], v[116:119], v[36:39]
  ds_read_b64_tr_b16 v[128:129], v172 offset:39424
  v_mfma_f32_16x16x32_bf16 v[56:59], v[148:151], v[120:123], v[56:59]
  ds_read_b64_tr_b16 v[130:131], v172 offset:40704
  v_mfma_f32_16x16x32_bf16 v[76:79], v[148:151], v[124:127], v[76:79]
  ds_read_b128 v[100:103], v168 offset:41472
  v_mfma_f32_16x16x32_bf16 v[20:23], v[152:155], v[112:115], v[20:23]
  ds_read_b64_tr_b16 v[132:133], v173 offset:39424
  v_mfma_f32_16x16x32_bf16 v[40:43], v[152:155], v[116:119], v[40:43]
  ds_read_b64_tr_b16 v[134:135], v173 offset:40704
  v_mfma_f32_16x16x32_bf16 v[60:63], v[152:155], v[120:123], v[60:63]
  ds_read_b128 v[104:107], v168 offset:43520
  v_mfma_f32_16x16x32_bf16 v[80:83], v[152:155], v[124:127], v[80:83]
  ds_read_b64_tr_b16 v[136:137], v174 offset:39424
  v_mfma_f32_16x16x32_bf16 v[24:27], v[156:159], v[112:115], v[24:27]
  ds_read_b64_tr_b16 v[138:139], v174 offset:40704
  v_mfma_f32_16x16x32_bf16 v[44:47], v[156:159], v[116:119], v[44:47]
  ds_read_b128 v[108:111], v168 offset:45568
  v_mfma_f32_16x16x32_bf16 v[64:67], v[156:159], v[120:123], v[64:67]
  ds_read_b64_tr_b16 v[140:141], v175 offset:39424
  v_mfma_f32_16x16x32_bf16 v[84:87], v[156:159], v[124:127], v[84:87]
  ds_read_b64_tr_b16 v[142:143], v175 offset:40704
  v_mfma_f32_16x16x32_bf16 v[28:31], v[160:163], v[112:115], v[28:31]
  ds_read_b64_tr_b16 v[144:145], v176 offset:39424
  v_mfma_f32_16x16x32_bf16 v[48:51], v[160:163], v[116:119], v[48:51]
  ds_read_b64_tr_b16 v[146:147], v176 offset:40704
  v_mfma_f32_16x16x32_bf16 v[68:71], v[160:163], v[120:123], v[68:71]
  v_mfma_f32_16x16x32_bf16 v[88:91], v[160:163], v[124:127], v[88:91]
  v_mfma_f32_16x16x32_bf16 v[32:35], v[164:167], v[112:115], v[32:35]
  v_mfma_f32_16x16x32_bf16 v[52:55], v[164:167], v[116:119], v[52:55]
  v_mfma_f32_16x16x32_bf16 v[72:75], v[164:167], v[120:123], v[72:75]
  v_mfma_f32_16x16x32_bf16 v[92:95], v[164:167], v[124:127], v[92:95]
  s_waitcnt lgkmcnt(0)
  v_mfma_f32_16x16x32_bf16 v[16:19], v[128:131], v[96:99], v[16:19]
  ds_read_b128 v[112:115], v169 offset:39424
  v_mfma_f32_16x16x32_bf16 v[36:39], v[128:131], v[100:103], v[36:39]
  ds_read_b64_tr_b16 v[148:149], v172 offset:49664
  v_mfma_f32_16x16x32_bf16 v[56:59], v[128:131], v[104:107], v[56:59]
  ds_read_b64_tr_b16 v[150:151], v172 offset:50944
  v_mfma_f32_16x16x32_bf16 v[76:79], v[128:131], v[108:111], v[76:79]
  ds_read_b128 v[116:119], v169 offset:41472
  v_mfma_f32_16x16x32_bf16 v[20:23], v[132:135], v[96:99], v[20:23]
  ds_read_b64_tr_b16 v[152:153], v173 offset:49664
  v_mfma_f32_16x16x32_bf16 v[40:43], v[132:135], v[100:103], v[40:43]
  ds_read_b64_tr_b16 v[154:155], v173 offset:50944
  v_mfma_f32_16x16x32_bf16 v[60:63], v[132:135], v[104:107], v[60:63]
  ds_read_b128 v[120:123], v169 offset:43520
  v_mfma_f32_16x16x32_bf16 v[80:83], v[132:135], v[108:111], v[80:83]
  ds_read_b64_tr_b16 v[156:157], v174 offset:49664
  v_mfma_f32_16x16x32_bf16 v[24:27], v[136:139], v[96:99], v[24:27]
  ds_read_b64_tr_b16 v[158:159], v174 offset:50944
  v_mfma_f32_16x16x32_bf16 v[44:47], v[136:139], v[100:103], v[44:47]
  ds_read_b128 v[124:127], v169 offset:45568
  v_mfma_f32_16x16x32_bf16 v[64:67], v[136:139], v[104:107], v[64:67]
  ds_read_b64_tr_b16 v[160:161], v175 offset:49664
  v_mfma_f32_16x16x32_bf16 v[84:87], v[136:139], v[108:111], v[84:87]
  ds_read_b64_tr_b16 v[162:163], v175 offset:50944
  v_mfma_f32_16x16x32_bf16 v[28:31], v[140:143], v[96:99], v[28:31]
  ds_read_b64_tr_b16 v[164:165], v176 offset:49664
  v_mfma_f32_16x16x32_bf16 v[48:51], v[140:143], v[100:103], v[48:51]
  ds_read_b64_tr_b16 v[166:167], v176 offset:50944
  v_mfma_f32_16x16x32_bf16 v[68:71], v[140:143], v[104:107], v[68:71]
  v_mfma_f32_16x16x32_bf16 v[88:91], v[140:143], v[108:111], v[88:91]
  v_mfma_f32_16x16x32_bf16 v[32:35], v[144:147], v[96:99], v[32:35]
  v_mfma_f32_16x16x32_bf16 v[52:55], v[144:147], v[100:103], v[52:55]
  v_mfma_f32_16x16x32_bf16 v[72:75], v[144:147], v[104:107], v[72:75]
  v_mfma_f32_16x16x32_bf16 v[92:95], v[144:147], v[108:111], v[92:95]
  s_waitcnt lgkmcnt(0)
  s_barrier
  v_mfma_f32_16x16x32_bf16 v[16:19], v[148:151], v[112:115], v[16:19]
  ds_read_b128 v[96:99], v170 offset:0
  v_mfma_f32_16x16x32_bf16 v[36:39], v[148:151], v[116:119], v[36:39]
  ds_read_b64_tr_b16 v[128:129], v177 offset:0
  v_mfma_f32_16x16x32_bf16 v[56:59], v[148:151], v[120:123], v[56:59]
  ds_read_b64_tr_b16 v[130:131], v177 offset:1280
  v_mfma_f32_16x16x32_bf16 v[76:79], v[148:151], v[124:127], v[76:79]
  ds_read_b128 v[100:103], v170 offset:2048
  v_mfma_f32_16x16x32_bf16 v[20:23], v[152:155], v[112:115], v[20:23]
  ds_read_b64_tr_b16 v[132:133], v178 offset:0
  v_mfma_f32_16x16x32_bf16 v[40:43], v[152:155], v[116:119], v[40:43]
  ds_read_b64_tr_b16 v[134:135], v178 offset:1280
  v_mfma_f32_16x16x32_bf16 v[60:63], v[152:155], v[120:123], v[60:63]
  ds_read_b128 v[104:107], v170 offset:4096
  v_mfma_f32_16x16x32_bf16 v[80:83], v[152:155], v[124:127], v[80:83]
  ds_read_b64_tr_b16 v[136:137], v179 offset:0
  v_mfma_f32_16x16x32_bf16 v[24:27], v[156:159], v[112:115], v[24:27]
  ds_read_b64_tr_b16 v[138:139], v179 offset:1280
  v_mfma_f32_16x16x32_bf16 v[44:47], v[156:159], v[116:119], v[44:47]
  ds_read_b128 v[108:111], v170 offset:6144
  v_mfma_f32_16x16x32_bf16 v[64:67], v[156:159], v[120:123], v[64:67]
  ds_read_b64_tr_b16 v[140:141], v180 offset:0
  v_mfma_f32_16x16x32_bf16 v[84:87], v[156:159], v[124:127], v[84:87]
  ds_read_b64_tr_b16 v[142:143], v180 offset:1280
  v_mfma_f32_16x16x32_bf16 v[28:31], v[160:163], v[112:115], v[28:31]
  ds_read_b64_tr_b16 v[144:145], v181 offset:0
  v_mfma_f32_16x16x32_bf16 v[48:51], v[160:163], v[116:119], v[48:51]
  ds_read_b64_tr_b16 v[146:147], v181 offset:1280
  v_mfma_f32_16x16x32_bf16 v[68:71], v[160:163], v[120:123], v[68:71]
  v_mfma_f32_16x16x32_bf16 v[88:91], v[160:163], v[124:127], v[88:91]
  v_mfma_f32_16x16x32_bf16 v[32:35], v[164:167], v[112:115], v[32:35]
  v_mfma_f32_16x16x32_bf16 v[52:55], v[164:167], v[116:119], v[52:55]
  v_mfma_f32_16x16x32_bf16 v[72:75], v[164:167], v[120:123], v[72:75]
  v_mfma_f32_16x16x32_bf16 v[92:95], v[164:167], v[124:127], v[92:95]
  s_waitcnt lgkmcnt(0)
  v_mfma_f32_16x16x32_bf16 v[16:19], v[128:131], v[96:99], v[16:19]
  ds_read_b128 v[112:115], v171 offset:0
  v_mfma_f32_16x16x32_bf16 v[36:39], v[128:131], v[100:103], v[36:39]
  ds_read_b64_tr_b16 v[148:149], v177 offset:10240
  v_mfma_f32_16x16x32_bf16 v[56:59], v[128:131], v[104:107], v[56:59]
  ds_read_b64_tr_b16 v[150:151], v177 offset:11520
  v_mfma_f32_16x16x32_bf16 v[76:79], v[128:131], v[108:111], v[76:79]
  ds_read_b128 v[116:119], v171 offset:2048
  v_mfma_f32_16x16x32_bf16 v[20:23], v[132:135], v[96:99], v[20:23]
  ds_read_b64_tr_b16 v[152:153], v178 offset:10240
  v_mfma_f32_16x16x32_bf16 v[40:43], v[132:135], v[100:103], v[40:43]
  ds_read_b64_tr_b16 v[154:155], v178 offset:11520
  v_mfma_f32_16x16x32_bf16 v[60:63], v[132:135], v[104:107], v[60:63]
  ds_read_b128 v[120:123], v171 offset:4096
  v_mfma_f32_16x16x32_bf16 v[80:83], v[132:135], v[108:111], v[80:83]
  ds_read_b64_tr_b16 v[156:157], v179 offset:10240
  v_mfma_f32_16x16x32_bf16 v[24:27], v[136:139], v[96:99], v[24:27]
  ds_read_b64_tr_b16 v[158:159], v179 offset:11520
  v_mfma_f32_16x16x32_bf16 v[44:47], v[136:139], v[100:103], v[44:47]
  ds_read_b128 v[124:127], v171 offset:6144
  v_mfma_f32_16x16x32_bf16 v[64:67], v[136:139], v[104:107], v[64:67]
  ds_read_b64_tr_b16 v[160:161], v180 offset:10240
  v_mfma_f32_16x16x32_bf16 v[84:87], v[136:139], v[108:111], v[84:87]
  ds_read_b64_tr_b16 v[162:163], v180 offset:11520
  v_mfma_f32_16x16x32_bf16 v[28:31], v[140:143], v[96:99], v[28:31]
  ds_read_b64_tr_b16 v[164:165], v181 offset:10240
  v_mfma_f32_16x16x32_bf16 v[48:51], v[140:143], v[100:103], v[48:51]
  ds_read_b64_tr_b16 v[166:167], v181 offset:11520
  v_mfma_f32_16x16x32_bf16 v[68:71], v[140:143], v[104:107], v[68:71]
  v_mfma_f32_16x16x32_bf16 v[88:91], v[140:143], v[108:111], v[88:91]
  v_mfma_f32_16x16x32_bf16 v[32:35], v[144:147], v[96:99], v[32:35]
  v_mfma_f32_16x16x32_bf16 v[52:55], v[144:147], v[100:103], v[52:55]
  v_mfma_f32_16x16x32_bf16 v[72:75], v[144:147], v[104:107], v[72:75]
  v_mfma_f32_16x16x32_bf16 v[92:95], v[144:147], v[108:111], v[92:95]
  s_waitcnt lgkmcnt(0)
  s_barrier
  v_mfma_f32_16x16x32_bf16 v[16:19], v[148:151], v[112:115], v[16:19]
  ds_read_b128 v[96:99], v170 offset:39424
  v_mfma_f32_16x16x32_bf16 v[36:39], v[148:151], v[116:119], v[36:39]
  ds_read_b64_tr_b16 v[128:129], v177 offset:39424
  v_mfma_f32_16x16x32_bf16 v[56:59], v[148:151], v[120:123], v[56:59]
  ds_read_b64_tr_b16 v[130:131], v177 offset:40704
  v_mfma_f32_16x16x32_bf16 v[76:79], v[148:151], v[124:127], v[76:79]
  ds_read_b128 v[100:103], v170 offset:41472
  v_mfma_f32_16x16x32_bf16 v[20:23], v[152:155], v[112:115], v[20:23]
  ds_read_b64_tr_b16 v[132:133], v178 offset:39424
  v_mfma_f32_16x16x32_bf16 v[40:43], v[152:155], v[116:119], v[40:43]
  ds_read_b64_tr_b16 v[134:135], v178 offset:40704
  v_mfma_f32_16x16x32_bf16 v[60:63], v[152:155], v[120:123], v[60:63]
  ds_read_b128 v[104:107], v170 offset:43520
  v_mfma_f32_16x16x32_bf16 v[80:83], v[152:155], v[124:127], v[80:83]
  ds_read_b64_tr_b16 v[136:137], v179 offset:39424
  v_mfma_f32_16x16x32_bf16 v[24:27], v[156:159], v[112:115], v[24:27]
  ds_read_b64_tr_b16 v[138:139], v179 offset:40704
  v_mfma_f32_16x16x32_bf16 v[44:47], v[156:159], v[116:119], v[44:47]
  ds_read_b128 v[108:111], v170 offset:45568
  v_mfma_f32_16x16x32_bf16 v[64:67], v[156:159], v[120:123], v[64:67]
  ds_read_b64_tr_b16 v[140:141], v180 offset:39424
  v_mfma_f32_16x16x32_bf16 v[84:87], v[156:159], v[124:127], v[84:87]
  ds_read_b64_tr_b16 v[142:143], v180 offset:40704
  v_mfma_f32_16x16x32_bf16 v[28:31], v[160:163], v[112:115], v[28:31]
  ds_read_b64_tr_b16 v[144:145], v181 offset:39424
  v_mfma_f32_16x16x32_bf16 v[48:51], v[160:163], v[116:119], v[48:51]
  ds_read_b64_tr_b16 v[146:147], v181 offset:40704
  v_mfma_f32_16x16x32_bf16 v[68:71], v[160:163], v[120:123], v[68:71]
  v_mfma_f32_16x16x32_bf16 v[88:91], v[160:163], v[124:127], v[88:91]
  v_mfma_f32_16x16x32_bf16 v[32:35], v[164:167], v[112:115], v[32:35]
  v_mfma_f32_16x16x32_bf16 v[52:55], v[164:167], v[116:119], v[52:55]
  v_mfma_f32_16x16x32_bf16 v[72:75], v[164:167], v[120:123], v[72:75]
  v_mfma_f32_16x16x32_bf16 v[92:95], v[164:167], v[124:127], v[92:95]
  s_waitcnt lgkmcnt(0)
  v_mfma_f32_16x16x32_bf16 v[16:19], v[128:131], v[96:99], v[16:19]
  ds_read_b128 v[112:115], v171 offset:39424
  v_mfma_f32_16x16x32_bf16 v[36:39], v[128:131], v[100:103], v[36:39]
  ds_read_b64_tr_b16 v[148:149], v177 offset:49664
  v_mfma_f32_16x16x32_bf16 v[56:59], v[128:131], v[104:107], v[56:59]
  ds_read_b64_tr_b16 v[150:151], v177 offset:50944
  v_mfma_f32_16x16x32_bf16 v[76:79], v[128:131], v[108:111], v[76:79]
  ds_read_b128 v[116:119], v171 offset:41472
  v_mfma_f32_16x16x32_bf16 v[20:23], v[132:135], v[96:99], v[20:23]
  ds_read_b64_tr_b16 v[152:153], v178 offset:49664
  v_mfma_f32_16x16x32_bf16 v[40:43], v[132:135], v[100:103], v[40:43]
  ds_read_b64_tr_b16 v[154:155], v178 offset:50944
  v_mfma_f32_16x16x32_bf16 v[60:63], v[132:135], v[104:107], v[60:63]
  ds_read_b128 v[120:123], v171 offset:43520
  v_mfma_f32_16x16x32_bf16 v[80:83], v[132:135], v[108:111], v[80:83]
  ds_read_b64_tr_b16 v[156:157], v179 offset:49664
  v_mfma_f32_16x16x32_bf16 v[24:27], v[136:139], v[96:99], v[24:27]
  ds_read_b64_tr_b16 v[158:159], v179 offset:50944
  v_mfma_f32_16x16x32_bf16 v[44:47], v[136:139], v[100:103], v[44:47]
  ds_read_b128 v[124:127], v171 offset:45568
  v_mfma_f32_16x16x32_bf16 v[64:67], v[136:139], v[104:107], v[64:67]
  ds_read_b64_tr_b16 v[160:161], v180 offset:49664
  v_mfma_f32_16x16x32_bf16 v[84:87], v[136:139], v[108:111], v[84:87]
  ds_read_b64_tr_b16 v[162:163], v180 offset:50944
  v_mfma_f32_16x16x32_bf16 v[28:31], v[140:143], v[96:99], v[28:31]
  ds_read_b64_tr_b16 v[164:165], v181 offset:49664
  v_mfma_f32_16x16x32_bf16 v[48:51], v[140:143], v[100:103], v[48:51]
  ds_read_b64_tr_b16 v[166:167], v181 offset:50944
  v_mfma_f32_16x16x32_bf16 v[68:71], v[140:143], v[104:107], v[68:71]
  v_mfma_f32_16x16x32_bf16 v[88:91], v[140:143], v[108:111], v[88:91]
  v_mfma_f32_16x16x32_bf16 v[32:35], v[144:147], v[96:99], v[32:35]
  v_mfma_f32_16x16x32_bf16 v[52:55], v[144:147], v[100:103], v[52:55]
  v_mfma_f32_16x16x32_bf16 v[72:75], v[144:147], v[104:107], v[72:75]
  v_mfma_f32_16x16x32_bf16 v[92:95], v[144:147], v[108:111], v[92:95]
  s_waitcnt lgkmcnt(0)
  s_barrier
  v_mfma_f32_16x16x32_bf16 v[16:19], v[148:151], v[112:115], v[16:19]
  ds_read_b128 v[96:99], v168 offset:0
  v_mfma_f32_16x16x32_bf16 v[36:39], v[148:151], v[116:119], v[36:39]
  ds_read_b64_tr_b16 v[128:129], v172 offset:0
  v_mfma_f32_16x16x32_bf16 v[56:59], v[148:151], v[120:123], v[56:59]
  ds_read_b64_tr_b16 v[130:131], v172 offset:1280
  v_mfma_f32_16x16x32_bf16 v[76:79], v[148:151], v[124:127], v[76:79]
  ds_read_b128 v[100:103], v168 offset:2048
  v_mfma_f32_16x16x32_bf16 v[20:23], v[152:155], v[112:115], v[20:23]
  ds_read_b64_tr_b16 v[132:133], v173 offset:0
  v_mfma_f32_16x16x32_bf16 v[40:43], v[152:155], v[116:119], v[40:43]
  ds_read_b64_tr_b16 v[134:135], v173 offset:1280
  v_mfma_f32_16x16x32_bf16 v[60:63], v[152:155], v[120:123], v[60:63]
  ds_read_b128 v[104:107], v168 offset:4096
  v_mfma_f32_16x16x32_bf16 v[80:83], v[152:155], v[124:127], v[80:83]
  ds_read_b64_tr_b16 v[136:137], v174 offset:0
  v_mfma_f32_16x16x32_bf16 v[24:27], v[156:159], v[112:115], v[24:27]
  ds_read_b64_tr_b16 v[138:139], v174 offset:1280
  v_mfma_f32_16x16x32_bf16 v[44:47], v[156:159], v[116:119], v[44:47]
  ds_read_b128 v[108:111], v168 offset:6144
  v_mfma_f32_16x16x32_bf16 v[64:67], v[156:159], v[120:123], v[64:67]
  ds_read_b64_tr_b16 v[140:141], v175 offset:0
  v_mfma_f32_16x16x32_bf16 v[84:87], v[156:159], v[124:127], v[84:87]
  ds_read_b64_tr_b16 v[142:143], v175 offset:1280
  v_mfma_f32_16x16x32_bf16 v[28:31], v[160:163], v[112:115], v[28:31]
  ds_read_b64_tr_b16 v[144:145], v176 offset:0
  v_mfma_f32_16x16x32_bf16 v[48:51], v[160:163], v[116:119], v[48:51]
  ds_read_b64_tr_b16 v[146:147], v176 offset:1280
  v_mfma_f32_16x16x32_bf16 v[68:71], v[160:163], v[120:123], v[68:71]
  v_mfma_f32_16x16x32_bf16 v[88:91], v[160:163], v[124:127], v[88:91]
  v_mfma_f32_16x16x32_bf16 v[32:35], v[164:167], v[112:115], v[32:35]
  v_mfma_f32_16x16x32_bf16 v[52:55], v[164:167], v[116:119], v[52:55]
  v_mfma_f32_16x16x32_bf16 v[72:75], v[164:167], v[120:123], v[72:75]
  v_mfma_f32_16x16x32_bf16 v[92:95], v[164:167], v[124:127], v[92:95]
  s_waitcnt lgkmcnt(0)
  v_mfma_f32_16x16x32_bf16 v[16:19], v[128:131], v[96:99], v[16:19]
  ds_read_b128 v[112:115], v169 offset:0
  v_mfma_f32_16x16x32_bf16 v[36:39], v[128:131], v[100:103], v[36:39]
  ds_read_b64_tr_b16 v[148:149], v172 offset:10240
  v_mfma_f32_16x16x32_bf16 v[56:59], v[128:131], v[104:107], v[56:59]
  ds_read_b64_tr_b16 v[150:151], v172 offset:11520
  v_mfma_f32_16x16x32_bf16 v[76:79], v[128:131], v[108:111], v[76:79]
  ds_read_b128 v[116:119], v169 offset:2048
  v_mfma_f32_16x16x32_bf16 v[20:23], v[132:135], v[96:99], v[20:23]
  ds_read_b64_tr_b16 v[152:153], v173 offset:10240
  v_mfma_f32_16x16x32_bf16 v[40:43], v[132:135], v[100:103], v[40:43]
  ds_read_b64_tr_b16 v[154:155], v173 offset:11520
  v_mfma_f32_16x16x32_bf16 v[60:63], v[132:135], v[104:107], v[60:63]
  ds_read_b128 v[120:123], v169 offset:4096
  v_mfma_f32_16x16x32_bf16 v[80:83], v[132:135], v[108:111], v[80:83]
  ds_read_b64_tr_b16 v[156:157], v174 offset:10240
  v_mfma_f32_16x16x32_bf16 v[24:27], v[136:139], v[96:99], v[24:27]
  ds_read_b64_tr_b16 v[158:159], v174 offset:11520
  v_mfma_f32_16x16x32_bf16 v[44:47], v[136:139], v[100:103], v[44:47]
  ds_read_b128 v[124:127], v169 offset:6144
  v_mfma_f32_16x16x32_bf16 v[64:67], v[136:139], v[104:107], v[64:67]
  ds_read_b64_tr_b16 v[160:161], v175 offset:10240
  v_mfma_f32_16x16x32_bf16 v[84:87], v[136:139], v[108:111], v[84:87]
  ds_read_b64_tr_b16 v[162:163], v175 offset:11520
  v_mfma_f32_16x16x32_bf16 v[28:31], v[140:143], v[96:99], v[28:31]
  ds_read_b64_tr_b16 v[164:165], v176 offset:10240
  v_mfma_f32_16x16x32_bf16 v[48:51], v[140:143], v[100:103], v[48:51]
  ds_read_b64_tr_b16 v[166:167], v176 offset:11520
  v_mfma_f32_16x16x32_bf16 v[68:71], v[140:143], v[104:107], v[68:71]
  v_mfma_f32_16x16x32_bf16 v[88:91], v[140:143], v[108:111], v[88:91]
  v_mfma_f32_16x16x32_bf16 v[32:35], v[144:147], v[96:99], v[32:35]
  v_mfma_f32_16x16x32_bf16 v[52:55], v[144:147], v[100:103], v[52:55]
  v_mfma_f32_16x16x32_bf16 v[72:75], v[144:147], v[104:107], v[72:75]
  v_mfma_f32_16x16x32_bf16 v[92:95], v[144:147], v[108:111], v[92:95]
  s_waitcnt lgkmcnt(0)
  s_barrier
  v_mfma_f32_16x16x32_bf16 v[16:19], v[148:151], v[112:115], v[16:19]
  ds_read_b128 v[96:99], v168 offset:39424
  v_mfma_f32_16x16x32_bf16 v[36:39], v[148:151], v[116:119], v[36:39]
  ds_read_b64_tr_b16 v[128:129], v172 offset:39424
  v_mfma_f32_16x16x32_bf16 v[56:59], v[148:151], v[120:123], v[56:59]
  ds_read_b64_tr_b16 v[130:131], v172 offset:40704
  v_mfma_f32_16x16x32_bf16 v[76:79], v[148:151], v[124:127], v[76:79]
  ds_read_b128 v[100:103], v168 offset:41472
  v_mfma_f32_16x16x32_bf16 v[20:23], v[152:155], v[112:115], v[20:23]
  ds_read_b64_tr_b16 v[132:133], v173 offset:39424
  v_mfma_f32_16x16x32_bf16 v[40:43], v[152:155], v[116:119], v[40:43]
  ds_read_b64_tr_b16 v[134:135], v173 offset:40704
  v_mfma_f32_16x16x32_bf16 v[60:63], v[152:155], v[120:123], v[60:63]
  ds_read_b128 v[104:107], v168 offset:43520
  v_mfma_f32_16x16x32_bf16 v[80:83], v[152:155], v[124:127], v[80:83]
  ds_read_b64_tr_b16 v[136:137], v174 offset:39424
  v_mfma_f32_16x16x32_bf16 v[24:27], v[156:159], v[112:115], v[24:27]
  ds_read_b64_tr_b16 v[138:139], v174 offset:40704
  v_mfma_f32_16x16x32_bf16 v[44:47], v[156:159], v[116:119], v[44:47]
  ds_read_b128 v[108:111], v168 offset:45568
  v_mfma_f32_16x16x32_bf16 v[64:67], v[156:159], v[120:123], v[64:67]
  ds_read_b64_tr_b16 v[140:141], v175 offset:39424
  v_mfma_f32_16x16x32_bf16 v[84:87], v[156:159], v[124:127], v[84:87]
  ds_read_b64_tr_b16 v[142:143], v175 offset:40704
  v_mfma_f32_16x16x32_bf16 v[28:31], v[160:163], v[112:115], v[28:31]
  ds_read_b64_tr_b16 v[144:145], v176 offset:39424
  v_mfma_f32_16x16x32_bf16 v[48:51], v[160:163], v[116:119], v[48:51]
  ds_read_b64_tr_b16 v[146:147], v176 offset:40704
  v_mfma_f32_16x16x32_bf16 v[68:71], v[160:163], v[120:123], v[68:71]
  v_mfma_f32_16x16x32_bf16 v[88:91], v[160:163], v[124:127], v[88:91]
  v_mfma_f32_16x16x32_bf16 v[32:35], v[164:167], v[112:115], v[32:35]
  v_mfma_f32_16x16x32_bf16 v[52:55], v[164:167], v[116:119], v[52:55]
  v_mfma_f32_16x16x32_bf16 v[72:75], v[164:167], v[120:123], v[72:75]
  v_mfma_f32_16x16x32_bf16 v[92:95], v[164:167], v[124:127], v[92:95]
  s_waitcnt lgkmcnt(0)
  v_mfma_f32_16x16x32_bf16 v[16:19], v[128:131], v[96:99], v[16:19]
  ds_read_b128 v[112:115], v169 offset:39424
  v_mfma_f32_16x16x32_bf16 v[36:39], v[128:131], v[100:103], v[36:39]
  ds_read_b64_tr_b16 v[148:149], v172 offset:49664
  v_mfma_f32_16x16x32_bf16 v[56:59], v[128:131], v[104:107], v[56:59]
  ds_read_b64_tr_b16 v[150:151], v172 offset:50944
  v_mfma_f32_16x16x32_bf16 v[76:79], v[128:131], v[108:111], v[76:79]
  ds_read_b128 v[116:119], v169 offset:41472
  v_mfma_f32_16x16x32_bf16 v[20:23], v[132:135], v[96:99], v[20:23]
  ds_read_b64_tr_b16 v[152:153], v173 offset:49664
  v_mfma_f32_16x16x32_bf16 v[40:43], v[132:135], v[100:103], v[40:43]
  ds_read_b64_tr_b16 v[154:155], v173 offset:50944
  v_mfma_f32_16x16x32_bf16 v[60:63], v[132:135], v[104:107], v[60:63]
  ds_read_b128 v[120:123], v169 offset:43520
  v_mfma_f32_16x16x32_bf16 v[80:83], v[132:135], v[108:111], v[80:83]
  ds_read_b64_tr_b16 v[156:157], v174 offset:49664
  v_mfma_f32_16x16x32_bf16 v[24:27], v[136:139], v[96:99], v[24:27]
  ds_read_b64_tr_b16 v[158:159], v174 offset:50944
  v_mfma_f32_16x16x32_bf16 v[44:47], v[136:139], v[100:103], v[44:47]
  ds_read_b128 v[124:127], v169 offset:45568
  v_mfma_f32_16x16x32_bf16 v[64:67], v[136:139], v[104:107], v[64:67]
  ds_read_b64_tr_b16 v[160:161], v175 offset:49664
  v_mfma_f32_16x16x32_bf16 v[84:87], v[136:139], v[108:111], v[84:87]
  ds_read_b64_tr_b16 v[162:163], v175 offset:50944
  v_mfma_f32_16x16x32_bf16 v[28:31], v[140:143], v[96:99], v[28:31]
  ds_read_b64_tr_b16 v[164:165], v176 offset:49664
  v_mfma_f32_16x16x32_bf16 v[48:51], v[140:143], v[100:103], v[48:51]
  ds_read_b64_tr_b16 v[166:167], v176 offset:50944
  v_mfma_f32_16x16x32_bf16 v[68:71], v[140:143], v[104:107], v[68:71]
  v_mfma_f32_16x16x32_bf16 v[88:91], v[140:143], v[108:111], v[88:91]
  v_mfma_f32_16x16x32_bf16 v[32:35], v[144:147], v[96:99], v[32:35]
  v_mfma_f32_16x16x32_bf16 v[52:55], v[144:147], v[100:103], v[52:55]
  v_mfma_f32_16x16x32_bf16 v[72:75], v[144:147], v[104:107], v[72:75]
  v_mfma_f32_16x16x32_bf16 v[92:95], v[144:147], v[108:111], v[92:95]
  s_waitcnt lgkmcnt(0)
  v_mfma_f32_16x16x32_bf16 v[16:19], v[148:151], v[112:115], v[16:19]
  v_mfma_f32_16x16x32_bf16 v[36:39], v[148:151], v[116:119], v[36:39]
  v_mfma_f32_16x16x32_bf16 v[56:59], v[148:151], v[120:123], v[56:59]
  v_mfma_f32_16x16x32_bf16 v[76:79], v[148:151], v[124:127], v[76:79]
  v_mfma_f32_16x16x32_bf16 v[20:23], v[152:155], v[112:115], v[20:23]
  v_mfma_f32_16x16x32_bf16 v[40:43], v[152:155], v[116:119], v[40:43]
  v_mfma_f32_16x16x32_bf16 v[60:63], v[152:155], v[120:123], v[60:63]
  v_mfma_f32_16x16x32_bf16 v[80:83], v[152:155], v[124:127], v[80:83]
  v_mfma_f32_16x16x32_bf16 v[24:27], v[156:159], v[112:115], v[24:27]
  v_mfma_f32_16x16x32_bf16 v[44:47], v[156:159], v[116:119], v[44:47]
  v_mfma_f32_16x16x32_bf16 v[64:67], v[156:159], v[120:123], v[64:67]
  v_mfma_f32_16x16x32_bf16 v[84:87], v[156:159], v[124:127], v[84:87]
  v_mfma_f32_16x16x32_bf16 v[28:31], v[160:163], v[112:115], v[28:31]
  v_mfma_f32_16x16x32_bf16 v[48:51], v[160:163], v[116:119], v[48:51]
  v_mfma_f32_16x16x32_bf16 v[68:71], v[160:163], v[120:123], v[68:71]
  v_mfma_f32_16x16x32_bf16 v[88:91], v[160:163], v[124:127], v[88:91]
  v_mfma_f32_16x16x32_bf16 v[32:35], v[164:167], v[112:115], v[32:35]
  v_mfma_f32_16x16x32_bf16 v[52:55], v[164:167], v[116:119], v[52:55]
  v_mfma_f32_16x16x32_bf16 v[72:75], v[164:167], v[120:123], v[72:75]
  v_mfma_f32_16x16x32_bf16 v[92:95], v[164:167], v[124:127], v[92:95]
  s_nop 7
  s_cmp_eq_u32 s21, 2
  s_cbranch_scc1 L_proj_kernel_epiK
  s_mov_b32 s32, 0x3ea52b5c
  v_mov_b32 v8, s32
  v_pk_mul_f32 v[16:17], v[16:17], v[8:9] op_sel_hi:[1,0]
  v_pk_mul_f32 v[18:19], v[18:19], v[8:9] op_sel_hi:[1,0]
  v_pk_mul_f32 v[36:37], v[36:37], v[8:9] op_sel_hi:[1,0]
  v_pk_mul_f32 v[38:39], v[38:39], v[8:9] op_sel_hi:[1,0]
  v_pk_mul_f32 v[56:57], v[56:57], v[8:9] op_sel_hi:[1,0]
  v_pk_mul_f32 v[58:59], v[58:59], v[8:9] op_sel_hi:[1,0]
  v_pk_mul_f32 v[76:77], v[76:77], v[8:9] op_sel_hi:[1,0]
  v_pk_mul_f32 v[78:79], v[78:79], v[8:9] op_sel_hi:[1,0]
  v_cvt_pk_bf16_f32 v16, v16, v17
  v_cvt_pk_bf16_f32 v17, v18, v19
  v_cvt_pk_bf16_f32 v18, v36, v37
  v_cvt_pk_bf16_f32 v19, v38, v39
  v_cvt_pk_bf16_f32 v56, v56, v57
  v_cvt_pk_bf16_f32 v57, v58, v59
  v_cvt_pk_bf16_f32 v58, v76, v77
  v_cvt_pk_bf16_f32 v59, v78, v79
  s_mul_i32 s33, s43, 0
  s_add_u32 s33, s33, s44
  v_permlane16_swap_b32 v16, v18
  v_permlane16_swap_b32 v17, v19
  buffer_store_dwordx4 v[16:19], v182, s[16:19], s33 offen offset:0 sc1
  v_permlane16_swap_b32 v56, v58
  v_permlane16_swap_b32 v57, v59
  buffer_store_dwordx4 v[56:59], v182, s[16:19], s33 offen offset:1280 sc1
  v_pk_mul_f32 v[20:21], v[20:21], v[8:9] op_sel_hi:[1,0]
  v_pk_mul_f32 v[22:23], v[22:23], v[8:9] op_sel_hi:[1,0]
  v_pk_mul_f32 v[40:41], v[40:41], v[8:9] op_sel_hi:[1,0]
  v_pk_mul_f32 v[42:43], v[42:43], v[8:9] op_sel_hi:[1,0]
  v_pk_mul_f32 v[60:61], v[60:61], v[8:9] op_sel_hi:[1,0]
  v_pk_mul_f32 v[62:63], v[62:63], v[8:9] op_sel_hi:[1,0]
  v_pk_mul_f32 v[80:81], v[80:81], v[8:9] op_sel_hi:[1,0]
  v_pk_mul_f32 v[82:83], v[82:83], v[8:9] op_sel_hi:[1,0]
  v_cvt_pk_bf16_f32 v20, v20, v21
  v_cvt_pk_bf16_f32 v21, v22, v23
  v_cvt_pk_bf16_f32 v22, v40, v41
  v_cvt_pk_bf16_f32 v23, v42, v43
  v_cvt_pk_bf16_f32 v60, v60, v61
  v_cvt_pk_bf16_f32 v61, v62, v63
  v_cvt_pk_bf16_f32 v62, v80, v81
  v_cvt_pk_bf16_f32 v63, v82, v83
  s_mul_i32 s33, s43, 1
  s_add_u32 s33, s33, s44
  v_permlane16_swap_b32 v20, v22
  v_permlane16_swap_b32 v21, v23
  buffer_store_dwordx4 v[20:23], v182, s[16:19], s33 offen offset:0 sc1
  v_permlane16_swap_b32 v60, v62
  v_permlane16_swap_b32 v61, v63
  buffer_store_dwordx4 v[60:63], v182, s[16:19], s33 offen offset:1280 sc1
  v_pk_mul_f32 v[24:25], v[24:25], v[8:9] op_sel_hi:[1,0]
  v_pk_mul_f32 v[26:27], v[26:27], v[8:9] op_sel_hi:[1,0]
  v_pk_mul_f32 v[44:45], v[44:45], v[8:9] op_sel_hi:[1,0]
  v_pk_mul_f32 v[46:47], v[46:47], v[8:9] op_sel_hi:[1,0]
  v_pk_mul_f32 v[64:65], v[64:65], v[8:9] op_sel_hi:[1,0]
  v_pk_mul_f32 v[66:67], v[66:67], v[8:9] op_sel_hi:[1,0]
  v_pk_mul_f32 v[84:85], v[84:85], v[8:9] op_sel_hi:[1,0]
  v_pk_mul_f32 v[86:87], v[86:87], v[8:9] op_sel_hi:[1,0]
  v_cvt_pk_bf16_f32 v24, v24, v25
  v_cvt_pk_bf16_f32 v25, v26, v27
  v_cvt_pk_bf16_f32 v26, v44, v45
  v_cvt_pk_bf16_f32 v27, v46, v47
  v_cvt_pk_bf16_f32 v64, v64, v65
  v_cvt_pk_bf16_f32 v65, v66, v67
  v_cvt_pk_bf16_f32 v66, v84, v85
  v_cvt_pk_bf16_f32 v67, v86, v87
  s_mul_i32 s33, s43, 2
  s_add_u32 s33, s33, s44
  v_permlane16_swap_b32 v24, v26
  v_permlane16_swap_b32 v25, v27
  buffer_store_dwordx4 v[24:27], v182, s[16:19], s33 offen offset:0 sc1
  v_permlane16_swap_b32 v64, v66
  v_permlane16_swap_b32 v65, v67
  buffer_store_dwordx4 v[64:67], v182, s[16:19], s33 offen offset:1280 sc1
  v_pk_mul_f32 v[28:29], v[28:29], v[8:9] op_sel_hi:[1,0]
  v_pk_mul_f32 v[30:31], v[30:31], v[8:9] op_sel_hi:[1,0]
  v_pk_mul_f32 v[48:49], v[48:49], v[8:9] op_sel_hi:[1,0]
  v_pk_mul_f32 v[50:51], v[50:51], v[8:9] op_sel_hi:[1,0]
  v_pk_mul_f32 v[68:69], v[68:69], v[8:9] op_sel_hi:[1,0]
  v_pk_mul_f32 v[70:71], v[70:71], v[8:9] op_sel_hi:[1,0]
  v_pk_mul_f32 v[88:89], v[88:89], v[8:9] op_sel_hi:[1,0]
  v_pk_mul_f32 v[90:91], v[90:91], v[8:9] op_sel_hi:[1,0]
  v_cvt_pk_bf16_f32 v28, v28, v29
  v_cvt_pk_bf16_f32 v29, v30, v31
  v_cvt_pk_bf16_f32 v30, v48, v49
  v_cvt_pk_bf16_f32 v31, v50, v51
  v_cvt_pk_bf16_f32 v68, v68, v69
  v_cvt_pk_bf16_f32 v69, v70, v71
  v_cvt_pk_bf16_f32 v70, v88, v89
  v_cvt_pk_bf16_f32 v71, v90, v91
  s_mul_i32 s33, s43, 3
  s_add_u32 s33, s33, s44
  v_permlane16_swap_b32 v28, v30
  v_permlane16_swap_b32 v29, v31
  buffer_store_dwordx4 v[28:31], v182, s[16:19], s33 offen offset:0 sc1
  v_permlane16_swap_b32 v68, v70
  v_permlane16_swap_b32 v69, v71
  buffer_store_dwordx4 v[68:71], v182, s[16:19], s33 offen offset:1280 sc1
  v_pk_mul_f32 v[32:33], v[32:33], v[8:9] op_sel_hi:[1,0]
  v_pk_mul_f32 v[34:35], v[34:35], v[8:9] op_sel_hi:[1,0]
  v_cvt_pk_bf16_f32 v32, v32, v33
  v_cvt_pk_bf16_f32 v33, v34, v35
  buffer_store_dwordx2 v[32:33], v183, s[16:19], s44 offen offset:1024 sc1
  v_pk_mul_f32 v[52:53], v[52:53], v[8:9] op_sel_hi:[1,0]
  v_pk_mul_f32 v[54:55], v[54:55], v[8:9] op_sel_hi:[1,0]
  v_cvt_pk_bf16_f32 v52, v52, v53
  v_cvt_pk_bf16_f32 v53, v54, v55
  buffer_store_dwordx2 v[52:53], v183, s[16:19], s44 offen offset:1152 sc1
  v_pk_mul_f32 v[72:73], v[72:73], v[8:9] op_sel_hi:[1,0]
  v_pk_mul_f32 v[74:75], v[74:75], v[8:9] op_sel_hi:[1,0]
  v_cvt_pk_bf16_f32 v72, v72, v73
  v_cvt_pk_bf16_f32 v73, v74, v75
  buffer_store_dwordx2 v[72:73], v183, s[16:19], s44 offen offset:2304 sc1
  v_pk_mul_f32 v[92:93], v[92:93], v[8:9] op_sel_hi:[1,0]
  v_pk_mul_f32 v[94:95], v[94:95], v[8:9] op_sel_hi:[1,0]
  v_cvt_pk_bf16_f32 v92, v92, v93
  v_cvt_pk_bf16_f32 v93, v94, v95
  buffer_store_dwordx2 v[92:93], v183, s[16:19], s44 offen offset:2432 sc1
  s_branch L_proj_kernel_fin
L_proj_kernel_epiK:
  v_cvt_pk_bf16_f32 v16, v16, v17
  v_cvt_pk_bf16_f32 v17, v18, v19
  v_cvt_pk_bf16_f32 v18, v36, v37
  v_cvt_pk_bf16_f32 v19, v38, v39
  v_cvt_pk_bf16_f32 v56, v56, v57
  v_cvt_pk_bf16_f32 v57, v58, v59
  v_cvt_pk_bf16_f32 v58, v76, v77
  v_cvt_pk_bf16_f32 v59, v78, v79
  s_mul_i32 s33, s43, 0
  s_add_u32 s33, s33, s44
  v_permlane16_swap_b32 v16, v18
  v_permlane16_swap_b32 v17, v19
  buffer_store_dwordx4 v[16:19], v182, s[16:19], s33 offen offset:0 sc1
  v_permlane16_swap_b32 v56, v58
  v_permlane16_swap_b32 v57, v59
  buffer_store_dwordx4 v[56:59], v182, s[16:19], s33 offen offset:1024 sc1
  v_cvt_pk_bf16_f32 v20, v20, v21
  v_cvt_pk_bf16_f32 v21, v22, v23
  v_cvt_pk_bf16_f32 v22, v40, v41
  v_cvt_pk_bf16_f32 v23, v42, v43
  v_cvt_pk_bf16_f32 v60, v60, v61
  v_cvt_pk_bf16_f32 v61, v62, v63
  v_cvt_pk_bf16_f32 v62, v80, v81
  v_cvt_pk_bf16_f32 v63, v82, v83
  s_mul_i32 s33, s43, 1
  s_add_u32 s33, s33, s44
  v_permlane16_swap_b32 v20, v22
  v_permlane16_swap_b32 v21, v23
  buffer_store_dwordx4 v[20:23], v182, s[16:19], s33 offen offset:0 sc1
  v_permlane16_swap_b32 v60, v62
  v_permlane16_swap_b32 v61, v63
  buffer_store_dwordx4 v[60:63], v182, s[16:19], s33 offen offset:1024 sc1
  v_cvt_pk_bf16_f32 v24, v24, v25
  v_cvt_pk_bf16_f32 v25, v26, v27
  v_cvt_pk_bf16_f32 v26, v44, v45
  v_cvt_pk_bf16_f32 v27, v46, v47
  v_cvt_pk_bf16_f32 v64, v64, v65
  v_cvt_pk_bf16_f32 v65, v66, v67
  v_cvt_pk_bf16_f32 v66, v84, v85
  v_cvt_pk_bf16_f32 v67, v86, v87
  s_mul_i32 s33, s43, 2
  s_add_u32 s33, s33, s44
  v_permlane16_swap_b32 v24, v26
  v_permlane16_swap_b32 v25, v27
  buffer_store_dwordx4 v[24:27], v182, s[16:19], s33 offen offset:0 sc1
  v_permlane16_swap_b32 v64, v66
  v_permlane16_swap_b32 v65, v67
  buffer_store_dwordx4 v[64:67], v182, s[16:19], s33 offen offset:1024 sc1
  v_cvt_pk_bf16_f32 v28, v28, v29
  v_cvt_pk_bf16_f32 v29, v30, v31
  v_cvt_pk_bf16_f32 v30, v48, v49
  v_cvt_pk_bf16_f32 v31, v50, v51
  v_cvt_pk_bf16_f32 v68, v68, v69
  v_cvt_pk_bf16_f32 v69, v70, v71
  v_cvt_pk_bf16_f32 v70, v88, v89
  v_cvt_pk_bf16_f32 v71, v90, v91
  s_mul_i32 s33, s43, 3
  s_add_u32 s33, s33, s44
  v_permlane16_swap_b32 v28, v30
  v_permlane16_swap_b32 v29, v31
  buffer_store_dwordx4 v[28:31], v182, s[16:19], s33 offen offset:0 sc1
  v_permlane16_swap_b32 v68, v70
  v_permlane16_swap_b32 v69, v71
  buffer_store_dwordx4 v[68:71], v182, s[16:19], s33 offen offset:1024 sc1
  v_cvt_pk_bf16_f32 v32, v32, v33
  v_cvt_pk_bf16_f32 v33, v34, v35
  buffer_store_dwordx2 v[32:33], v183, s[16:19], s44 offen offset:2048 sc1
  v_cvt_pk_bf16_f32 v52, v52, v53
  v_cvt_pk_bf16_f32 v53, v54, v55
  buffer_store_dwordx2 v[52:53], v183, s[16:19], s44 offen offset:2176 sc1
  v_cvt_pk_bf16_f32 v72, v72, v73
  v_cvt_pk_bf16_f32 v73, v74, v75
  buffer_store_dwordx2 v[72:73], v183, s[16:19], s44 offen offset:2304 sc1
  v_cvt_pk_bf16_f32 v92, v92, v93
  v_cvt_pk_bf16_f32 v93, v94, v95
  buffer_store_dwordx2 v[92:93], v183, s[16:19], s44 offen offset:2432 sc1
L_proj_kernel_fin:
  s_endpgm
L_proj_kernel_consV:
  s_waitcnt lgkmcnt(0)
  v_mfma_f32_16x16x32_bf16 v[16:19], v[96:99], v[128:131], 0
  ds_read_b128 v[112:115], v169 offset:0
  v_mfma_f32_16x16x32_bf16 v[36:39], v[100:103], v[128:131], 0
  ds_read_b64_tr_b16 v[148:149], v172 offset:10240
  v_mfma_f32_16x16x32_bf16 v[56:59], v[104:107], v[128:131], 0
  ds_read_b64_tr_b16 v[150:151], v172 offset:11520
  v_mfma_f32_16x16x32_bf16 v[76:79], v[108:111], v[128:131], 0
  ds_read_b128 v[116:119], v169 offset:2048
  v_mfma_f32_16x16x32_bf16 v[20:23], v[96:99], v[132:135], 0
  ds_read_b64_tr_b16 v[152:153], v173 offset:10240
  v_mfma_f32_16x16x32_bf16 v[40:43], v[100:103], v[132:135], 0
  ds_read_b64_tr_b16 v[154:155], v173 offset:11520
  v_mfma_f32_16x16x32_bf16 v[60:63], v[104:107], v[132:135], 0
  ds_read_b128 v[120:123], v169 offset:4096
  v_mfma_f32_16x16x32_bf16 v[80:83], v[108:111], v[132:135], 0
  ds_read_b64_tr_b16 v[156:157], v174 offset:10240
  v_mfma_f32_16x16x32_bf16 v[24:27], v[96:99], v[136:139], 0
  ds_read_b64_tr_b16 v[158:159], v174 offset:11520
  v_mfma_f32_16x16x32_bf16 v[44:47], v[100:103], v[136:139], 0
  ds_read_b128 v[124:127], v169 offset:6144
  v_mfma_f32_16x16x32_bf16 v[64:67], v[104:107], v[136:139], 0
  ds_read_b64_tr_b16 v[160:161], v175 offset:10240
  v_mfma_f32_16x16x32_bf16 v[84:87], v[108:111], v[136:139], 0
  ds_read_b64_tr_b16 v[162:163], v175 offset:11520
  v_mfma_f32_16x16x32_bf16 v[28:31], v[96:99], v[140:143], 0
  ds_read_b64_tr_b16 v[164:165], v176 offset:10240
  v_mfma_f32_16x16x32_bf16 v[48:51], v[100:103], v[140:143], 0
  ds_read_b64_tr_b16 v[166:167], v176 offset:11520
  v_mfma_f32_16x16x32_bf16 v[68:71], v[104:107], v[140:143], 0
  v_mfma_f32_16x16x32_bf16 v[88:91], v[108:111], v[140:143], 0
  v_mfma_f32_16x16x32_bf16 v[32:35], v[96:99], v[144:147], 0
  v_mfma_f32_16x16x32_bf16 v[52:55], v[100:103], v[144:147], 0
  v_mfma_f32_16x16x32_bf16 v[72:75], v[104:107], v[144:147], 0
  v_mfma_f32_16x16x32_bf16 v[92:95], v[108:111], v[144:147], 0
  s_waitcnt lgkmcnt(0)
  s_barrier
  v_mfma_f32_16x16x32_bf16 v[16:19], v[112:115], v[148:151], v[16:19]
  ds_read_b128 v[96:99], v168 offset:39424
  v_mfma_f32_16x16x32_bf16 v[36:39], v[116:119], v[148:151], v[36:39]
  ds_read_b64_tr_b16 v[128:129], v172 offset:39424
  v_mfma_f32_16x16x32_bf16 v[56:59], v[120:123], v[148:151], v[56:59]
  ds_read_b64_tr_b16 v[130:131], v172 offset:40704
  v_mfma_f32_16x16x32_bf16 v[76:79], v[124:127], v[148:151], v[76:79]
  ds_read_b128 v[100:103], v168 offset:41472
  v_mfma_f32_16x16x32_bf16 v[20:23], v[112:115], v[152:155], v[20:23]
  ds_read_b64_tr_b16 v[132:133], v173 offset:39424
  v_mfma_f32_16x16x32_bf16 v[40:43], v[116:119], v[152:155], v[40:43]
  ds_read_b64_tr_b16 v[134:135], v173 offset:40704
  v_mfma_f32_16x16x32_bf16 v[60:63], v[120:123], v[152:155], v[60:63]
  ds_read_b128 v[104:107], v168 offset:43520
  v_mfma_f32_16x16x32_bf16 v[80:83], v[124:127], v[152:155], v[80:83]
  ds_read_b64_tr_b16 v[136:137], v174 offset:39424
  v_mfma_f32_16x16x32_bf16 v[24:27], v[112:115], v[156:159], v[24:27]
  ds_read_b64_tr_b16 v[138:139], v174 offset:40704
  v_mfma_f32_16x16x32_bf16 v[44:47], v[116:119], v[156:159], v[44:47]
  ds_read_b128 v[108:111], v168 offset:45568
  v_mfma_f32_16x16x32_bf16 v[64:67], v[120:123], v[156:159], v[64:67]
  ds_read_b64_tr_b16 v[140:141], v175 offset:39424
  v_mfma_f32_16x16x32_bf16 v[84:87], v[124:127], v[156:159], v[84:87]
  ds_read_b64_tr_b16 v[142:143], v175 offset:40704
  v_mfma_f32_16x16x32_bf16 v[28:31], v[112:115], v[160:163], v[28:31]
  ds_read_b64_tr_b16 v[144:145], v176 offset:39424
  v_mfma_f32_16x16x32_bf16 v[48:51], v[116:119], v[160:163], v[48:51]
  ds_read_b64_tr_b16 v[146:147], v176 offset:40704
  v_mfma_f32_16x16x32_bf16 v[68:71], v[120:123], v[160:163], v[68:71]
  v_mfma_f32_16x16x32_bf16 v[88:91], v[124:127], v[160:163], v[88:91]
  v_mfma_f32_16x16x32_bf16 v[32:35], v[112:115], v[164:167], v[32:35]
  v_mfma_f32_16x16x32_bf16 v[52:55], v[116:119], v[164:167], v[52:55]
  v_mfma_f32_16x16x32_bf16 v[72:75], v[120:123], v[164:167], v[72:75]
  v_mfma_f32_16x16x32_bf16 v[92:95], v[124:127], v[164:167], v[92:95]
  s_waitcnt lgkmcnt(0)
  v_mfma_f32_16x16x32_bf16 v[16:19], v[96:99], v[128:131], v[16:19]
  ds_read_b128 v[112:115], v169 offset:39424
  v_mfma_f32_16x16x32_bf16 v[36:39], v[100:103], v[128:131], v[36:39]
  ds_read_b64_tr_b16 v[148:149], v172 offset:49664
  v_mfma_f32_16x16x32_bf16 v[56:59], v[104:107], v[128:131], v[56:59]
  ds_read_b64_tr_b16 v[150:151], v172 offset:50944
  v_mfma_f32_16x16x32_bf16 v[76:79], v[108:111], v[128:131], v[76:79]
  ds_read_b128 v[116:119], v169 offset:41472
  v_mfma_f32_16x16x32_bf16 v[20:23], v[96:99], v[132:135], v[20:23]
  ds_read_b64_tr_b16 v[152:153], v173 offset:49664
  v_mfma_f32_16x16x32_bf16 v[40:43], v[100:103], v[132:135], v[40:43]
  ds_read_b64_tr_b16 v[154:155], v173 offset:50944
  v_mfma_f32_16x16x32_bf16 v[60:63], v[104:107], v[132:135], v[60:63]
  ds_read_b128 v[120:123], v169 offset:43520
  v_mfma_f32_16x16x32_bf16 v[80:83], v[108:111], v[132:135], v[80:83]
  ds_read_b64_tr_b16 v[156:157], v174 offset:49664
  v_mfma_f32_16x16x32_bf16 v[24:27], v[96:99], v[136:139], v[24:27]
  ds_read_b64_tr_b16 v[158:159], v174 offset:50944
  v_mfma_f32_16x16x32_bf16 v[44:47], v[100:103], v[136:139], v[44:47]
  ds_read_b128 v[124:127], v169 offset:45568
  v_mfma_f32_16x16x32_bf16 v[64:67], v[104:107], v[136:139], v[64:67]
  ds_read_b64_tr_b16 v[160:161], v175 offset:49664
  v_mfma_f32_16x16x32_bf16 v[84:87], v[108:111], v[136:139], v[84:87]
  ds_read_b64_tr_b16 v[162:163], v175 offset:50944
  v_mfma_f32_16x16x32_bf16 v[28:31], v[96:99], v[140:143], v[28:31]
  ds_read_b64_tr_b16 v[164:165], v176 offset:49664
  v_mfma_f32_16x16x32_bf16 v[48:51], v[100:103], v[140:143], v[48:51]
  ds_read_b64_tr_b16 v[166:167], v176 offset:50944
  v_mfma_f32_16x16x32_bf16 v[68:71], v[104:107], v[140:143], v[68:71]
  v_mfma_f32_16x16x32_bf16 v[88:91], v[108:111], v[140:143], v[88:91]
  v_mfma_f32_16x16x32_bf16 v[32:35], v[96:99], v[144:147], v[32:35]
  v_mfma_f32_16x16x32_bf16 v[52:55], v[100:103], v[144:147], v[52:55]
  v_mfma_f32_16x16x32_bf16 v[72:75], v[104:107], v[144:147], v[72:75]
  v_mfma_f32_16x16x32_bf16 v[92:95], v[108:111], v[144:147], v[92:95]
  s_waitcnt lgkmcnt(0)
  s_barrier
  v_mfma_f32_16x16x32_bf16 v[16:19], v[112:115], v[148:151], v[16:19]
  ds_read_b128 v[96:99], v170 offset:0
  v_mfma_f32_16x16x32_bf16 v[36:39], v[116:119], v[148:151], v[36:39]
  ds_read_b64_tr_b16 v[128:129], v177 offset:0
  v_mfma_f32_16x16x32_bf16 v[56:59], v[120:123], v[148:151], v[56:59]
  ds_read_b64_tr_b16 v[130:131], v177 offset:1280
  v_mfma_f32_16x16x32_bf16 v[76:79], v[124:127], v[148:151], v[76:79]
  ds_read_b128 v[100:103], v170 offset:2048
  v_mfma_f32_16x16x32_bf16 v[20:23], v[112:115], v[152:155], v[20:23]
  ds_read_b64_tr_b16 v[132:133], v178 offset:0
  v_mfma_f32_16x16x32_bf16 v[40:43], v[116:119], v[152:155], v[40:43]
  ds_read_b64_tr_b16 v[134:135], v178 offset:1280
  v_mfma_f32_16x16x32_bf16 v[60:63], v[120:123], v[152:155], v[60:63]
  ds_read_b128 v[104:107], v170 offset:4096
  v_mfma_f32_16x16x32_bf16 v[80:83], v[124:127], v[152:155], v[80:83]
  ds_read_b64_tr_b16 v[136:137], v179 offset:0
  v_mfma_f32_16x16x32_bf16 v[24:27], v[112:115], v[156:159], v[24:27]
  ds_read_b64_tr_b16 v[138:139], v179 offset:1280
  v_mfma_f32_16x16x32_bf16 v[44:47], v[116:119], v[156:159], v[44:47]
  ds_read_b128 v[108:111], v170 offset:6144
  v_mfma_f32_16x16x32_bf16 v[64:67], v[120:123], v[156:159], v[64:67]
  ds_read_b64_tr_b16 v[140:141], v180 offset:0
  v_mfma_f32_16x16x32_bf16 v[84:87], v[124:127], v[156:159], v[84:87]
  ds_read_b64_tr_b16 v[142:143], v180 offset:1280
  v_mfma_f32_16x16x32_bf16 v[28:31], v[112:115], v[160:163], v[28:31]
  ds_read_b64_tr_b16 v[144:145], v181 offset:0
  v_mfma_f32_16x16x32_bf16 v[48:51], v[116:119], v[160:163], v[48:51]
  ds_read_b64_tr_b16 v[146:147], v181 offset:1280
  v_mfma_f32_16x16x32_bf16 v[68:71], v[120:123], v[160:163], v[68:71]
  v_mfma_f32_16x16x32_bf16 v[88:91], v[124:127], v[160:163], v[88:91]
  v_mfma_f32_16x16x32_bf16 v[32:35], v[112:115], v[164:167], v[32:35]
  v_mfma_f32_16x16x32_bf16 v[52:55], v[116:119], v[164:167], v[52:55]
  v_mfma_f32_16x16x32_bf16 v[72:75], v[120:123], v[164:167], v[72:75]
  v_mfma_f32_16x16x32_bf16 v[92:95], v[124:127], v[164:167], v[92:95]
  s_waitcnt lgkmcnt(0)
  v_mfma_f32_16x16x32_bf16 v[16:19], v[96:99], v[128:131], v[16:19]
  ds_read_b128 v[112:115], v171 offset:0
  v_mfma_f32_16x16x32_bf16 v[36:39], v[100:103], v[128:131], v[36:39]
  ds_read_b64_tr_b16 v[148:149], v177 offset:10240
  v_mfma_f32_16x16x32_bf16 v[56:59], v[104:107], v[128:131], v[56:59]
  ds_read_b64_tr_b16 v[150:151], v177 offset:11520
  v_mfma_f32_16x16x32_bf16 v[76:79], v[108:111], v[128:131], v[76:79]
  ds_read_b128 v[116:119], v171 offset:2048
  v_mfma_f32_16x16x32_bf16 v[20:23], v[96:99], v[132:135], v[20:23]
  ds_read_b64_tr_b16 v[152:153], v178 offset:10240
  v_mfma_f32_16x16x32_bf16 v[40:43], v[100:103], v[132:135], v[40:43]
  ds_read_b64_tr_b16 v[154:155], v178 offset:11520
  v_mfma_f32_16x16x32_bf16 v[60:63], v[104:107], v[132:135], v[60:63]
  ds_read_b128 v[120:123], v171 offset:4096
  v_mfma_f32_16x16x32_bf16 v[80:83], v[108:111], v[132:135], v[80:83]
  ds_read_b64_tr_b16 v[156:157], v179 offset:10240
  v_mfma_f32_16x16x32_bf16 v[24:27], v[96:99], v[136:139], v[24:27]
  ds_read_b64_tr_b16 v[158:159], v179 offset:11520
  v_mfma_f32_16x16x32_bf16 v[44:47], v[100:103], v[136:139], v[44:47]
  ds_read_b128 v[124:127], v171 offset:6144
  v_mfma_f32_16x16x32_bf16 v[64:67], v[104:107], v[136:139], v[64:67]
  ds_read_b64_tr_b16 v[160:161], v180 offset:10240
  v_mfma_f32_16x16x32_bf16 v[84:87], v[108:111], v[136:139], v[84:87]
  ds_read_b64_tr_b16 v[162:163], v180 offset:11520
  v_mfma_f32_16x16x32_bf16 v[28:31], v[96:99], v[140:143], v[28:31]
  ds_read_b64_tr_b16 v[164:165], v181 offset:10240
  v_mfma_f32_16x16x32_bf16 v[48:51], v[100:103], v[140:143], v[48:51]
  ds_read_b64_tr_b16 v[166:167], v181 offset:11520
  v_mfma_f32_16x16x32_bf16 v[68:71], v[104:107], v[140:143], v[68:71]
  v_mfma_f32_16x16x32_bf16 v[88:91], v[108:111], v[140:143], v[88:91]
  v_mfma_f32_16x16x32_bf16 v[32:35], v[96:99], v[144:147], v[32:35]
  v_mfma_f32_16x16x32_bf16 v[52:55], v[100:103], v[144:147], v[52:55]
  v_mfma_f32_16x16x32_bf16 v[72:75], v[104:107], v[144:147], v[72:75]
  v_mfma_f32_16x16x32_bf16 v[92:95], v[108:111], v[144:147], v[92:95]
  s_waitcnt lgkmcnt(0)
  s_barrier
  v_mfma_f32_16x16x32_bf16 v[16:19], v[112:115], v[148:151], v[16:19]
  ds_read_b128 v[96:99], v170 offset:39424
  v_mfma_f32_16x16x32_bf16 v[36:39], v[116:119], v[148:151], v[36:39]
  ds_read_b64_tr_b16 v[128:129], v177 offset:39424
  v_mfma_f32_16x16x32_bf16 v[56:59], v[120:123], v[148:151], v[56:59]
  ds_read_b64_tr_b16 v[130:131], v177 offset:40704
  v_mfma_f32_16x16x32_bf16 v[76:79], v[124:127], v[148:151], v[76:79]
  ds_read_b128 v[100:103], v170 offset:41472
  v_mfma_f32_16x16x32_bf16 v[20:23], v[112:115], v[152:155], v[20:23]
  ds_read_b64_tr_b16 v[132:133], v178 offset:39424
  v_mfma_f32_16x16x32_bf16 v[40:43], v[116:119], v[152:155], v[40:43]
  ds_read_b64_tr_b16 v[134:135], v178 offset:40704
  v_mfma_f32_16x16x32_bf16 v[60:63], v[120:123], v[152:155], v[60:63]
  ds_read_b128 v[104:107], v170 offset:43520
  v_mfma_f32_16x16x32_bf16 v[80:83], v[124:127], v[152:155], v[80:83]
  ds_read_b64_tr_b16 v[136:137], v179 offset:39424
  v_mfma_f32_16x16x32_bf16 v[24:27], v[112:115], v[156:159], v[24:27]
  ds_read_b64_tr_b16 v[138:139], v179 offset:40704
  v_mfma_f32_16x16x32_bf16 v[44:47], v[116:119], v[156:159], v[44:47]
  ds_read_b128 v[108:111], v170 offset:45568
  v_mfma_f32_16x16x32_bf16 v[64:67], v[120:123], v[156:159], v[64:67]
  ds_read_b64_tr_b16 v[140:141], v180 offset:39424
  v_mfma_f32_16x16x32_bf16 v[84:87], v[124:127], v[156:159], v[84:87]
  ds_read_b64_tr_b16 v[142:143], v180 offset:40704
  v_mfma_f32_16x16x32_bf16 v[28:31], v[112:115], v[160:163], v[28:31]
  ds_read_b64_tr_b16 v[144:145], v181 offset:39424
  v_mfma_f32_16x16x32_bf16 v[48:51], v[116:119], v[160:163], v[48:51]
  ds_read_b64_tr_b16 v[146:147], v181 offset:40704
  v_mfma_f32_16x16x32_bf16 v[68:71], v[120:123], v[160:163], v[68:71]
  v_mfma_f32_16x16x32_bf16 v[88:91], v[124:127], v[160:163], v[88:91]
  v_mfma_f32_16x16x32_bf16 v[32:35], v[112:115], v[164:167], v[32:35]
  v_mfma_f32_16x16x32_bf16 v[52:55], v[116:119], v[164:167], v[52:55]
  v_mfma_f32_16x16x32_bf16 v[72:75], v[120:123], v[164:167], v[72:75]
  v_mfma_f32_16x16x32_bf16 v[92:95], v[124:127], v[164:167], v[92:95]
  s_waitcnt lgkmcnt(0)
  v_mfma_f32_16x16x32_bf16 v[16:19], v[96:99], v[128:131], v[16:19]
  ds_read_b128 v[112:115], v171 offset:39424
  v_mfma_f32_16x16x32_bf16 v[36:39], v[100:103], v[128:131], v[36:39]
  ds_read_b64_tr_b16 v[148:149], v177 offset:49664
  v_mfma_f32_16x16x32_bf16 v[56:59], v[104:107], v[128:131], v[56:59]
  ds_read_b64_tr_b16 v[150:151], v177 offset:50944
  v_mfma_f32_16x16x32_bf16 v[76:79], v[108:111], v[128:131], v[76:79]
  ds_read_b128 v[116:119], v171 offset:41472
  v_mfma_f32_16x16x32_bf16 v[20:23], v[96:99], v[132:135], v[20:23]
  ds_read_b64_tr_b16 v[152:153], v178 offset:49664
  v_mfma_f32_16x16x32_bf16 v[40:43], v[100:103], v[132:135], v[40:43]
  ds_read_b64_tr_b16 v[154:155], v178 offset:50944
  v_mfma_f32_16x16x32_bf16 v[60:63], v[104:107], v[132:135], v[60:63]
  ds_read_b128 v[120:123], v171 offset:43520
  v_mfma_f32_16x16x32_bf16 v[80:83], v[108:111], v[132:135], v[80:83]
  ds_read_b64_tr_b16 v[156:157], v179 offset:49664
  v_mfma_f32_16x16x32_bf16 v[24:27], v[96:99], v[136:139], v[24:27]
  ds_read_b64_tr_b16 v[158:159], v179 offset:50944
  v_mfma_f32_16x16x32_bf16 v[44:47], v[100:103], v[136:139], v[44:47]
  ds_read_b128 v[124:127], v171 offset:45568
  v_mfma_f32_16x16x32_bf16 v[64:67], v[104:107], v[136:139], v[64:67]
  ds_read_b64_tr_b16 v[160:161], v180 offset:49664
  v_mfma_f32_16x16x32_bf16 v[84:87], v[108:111], v[136:139], v[84:87]
  ds_read_b64_tr_b16 v[162:163], v180 offset:50944
  v_mfma_f32_16x16x32_bf16 v[28:31], v[96:99], v[140:143], v[28:31]
  ds_read_b64_tr_b16 v[164:165], v181 offset:49664
  v_mfma_f32_16x16x32_bf16 v[48:51], v[100:103], v[140:143], v[48:51]
  ds_read_b64_tr_b16 v[166:167], v181 offset:50944
  v_mfma_f32_16x16x32_bf16 v[68:71], v[104:107], v[140:143], v[68:71]
  v_mfma_f32_16x16x32_bf16 v[88:91], v[108:111], v[140:143], v[88:91]
  v_mfma_f32_16x16x32_bf16 v[32:35], v[96:99], v[144:147], v[32:35]
  v_mfma_f32_16x16x32_bf16 v[52:55], v[100:103], v[144:147], v[52:55]
  v_mfma_f32_16x16x32_bf16 v[72:75], v[104:107], v[144:147], v[72:75]
  v_mfma_f32_16x16x32_bf16 v[92:95], v[108:111], v[144:147], v[92:95]
  s_waitcnt lgkmcnt(0)
  s_barrier
  v_mfma_f32_16x16x32_bf16 v[16:19], v[112:115], v[148:151], v[16:19]
  ds_read_b128 v[96:99], v168 offset:0
  v_mfma_f32_16x16x32_bf16 v[36:39], v[116:119], v[148:151], v[36:39]
  ds_read_b64_tr_b16 v[128:129], v172 offset:0
  v_mfma_f32_16x16x32_bf16 v[56:59], v[120:123], v[148:151], v[56:59]
  ds_read_b64_tr_b16 v[130:131], v172 offset:1280
  v_mfma_f32_16x16x32_bf16 v[76:79], v[124:127], v[148:151], v[76:79]
  ds_read_b128 v[100:103], v168 offset:2048
  v_mfma_f32_16x16x32_bf16 v[20:23], v[112:115], v[152:155], v[20:23]
  ds_read_b64_tr_b16 v[132:133], v173 offset:0
  v_mfma_f32_16x16x32_bf16 v[40:43], v[116:119], v[152:155], v[40:43]
  ds_read_b64_tr_b16 v[134:135], v173 offset:1280
  v_mfma_f32_16x16x32_bf16 v[60:63], v[120:123], v[152:155], v[60:63]
  ds_read_b128 v[104:107], v168 offset:4096
  v_mfma_f32_16x16x32_bf16 v[80:83], v[124:127], v[152:155], v[80:83]
  ds_read_b64_tr_b16 v[136:137], v174 offset:0
  v_mfma_f32_16x16x32_bf16 v[24:27], v[112:115], v[156:159], v[24:27]
  ds_read_b64_tr_b16 v[138:139], v174 offset:1280
  v_mfma_f32_16x16x32_bf16 v[44:47], v[116:119], v[156:159], v[44:47]
  ds_read_b128 v[108:111], v168 offset:6144
  v_mfma_f32_16x16x32_bf16 v[64:67], v[120:123], v[156:159], v[64:67]
  ds_read_b64_tr_b16 v[140:141], v175 offset:0
  v_mfma_f32_16x16x32_bf16 v[84:87], v[124:127], v[156:159], v[84:87]
  ds_read_b64_tr_b16 v[142:143], v175 offset:1280
  v_mfma_f32_16x16x32_bf16 v[28:31], v[112:115], v[160:163], v[28:31]
  ds_read_b64_tr_b16 v[144:145], v176 offset:0
  v_mfma_f32_16x16x32_bf16 v[48:51], v[116:119], v[160:163], v[48:51]
  ds_read_b64_tr_b16 v[146:147], v176 offset:1280
  v_mfma_f32_16x16x32_bf16 v[68:71], v[120:123], v[160:163], v[68:71]
  v_mfma_f32_16x16x32_bf16 v[88:91], v[124:127], v[160:163], v[88:91]
  v_mfma_f32_16x16x32_bf16 v[32:35], v[112:115], v[164:167], v[32:35]
  v_mfma_f32_16x16x32_bf16 v[52:55], v[116:119], v[164:167], v[52:55]
  v_mfma_f32_16x16x32_bf16 v[72:75], v[120:123], v[164:167], v[72:75]
  v_mfma_f32_16x16x32_bf16 v[92:95], v[124:127], v[164:167], v[92:95]
  s_waitcnt lgkmcnt(0)
  v_mfma_f32_16x16x32_bf16 v[16:19], v[96:99], v[128:131], v[16:19]
  ds_read_b128 v[112:115], v169 offset:0
  v_mfma_f32_16x16x32_bf16 v[36:39], v[100:103], v[128:131], v[36:39]
  ds_read_b64_tr_b16 v[148:149], v172 offset:10240
  v_mfma_f32_16x16x32_bf16 v[56:59], v[104:107], v[128:131], v[56:59]
  ds_read_b64_tr_b16 v[150:151], v172 offset:11520
  v_mfma_f32_16x16x32_bf16 v[76:79], v[108:111], v[128:131], v[76:79]
  ds_read_b128 v[116:119], v169 offset:2048
  v_mfma_f32_16x16x32_bf16 v[20:23], v[96:99], v[132:135], v[20:23]
  ds_read_b64_tr_b16 v[152:153], v173 offset:10240
  v_mfma_f32_16x16x32_bf16 v[40:43], v[100:103], v[132:135], v[40:43]
  ds_read_b64_tr_b16 v[154:155], v173 offset:11520
  v_mfma_f32_16x16x32_bf16 v[60:63], v[104:107], v[132:135], v[60:63]
  ds_read_b128 v[120:123], v169 offset:4096
  v_mfma_f32_16x16x32_bf16 v[80:83], v[108:111], v[132:135], v[80:83]
  ds_read_b64_tr_b16 v[156:157], v174 offset:10240
  v_mfma_f32_16x16x32_bf16 v[24:27], v[96:99], v[136:139], v[24:27]
  ds_read_b64_tr_b16 v[158:159], v174 offset:11520
  v_mfma_f32_16x16x32_bf16 v[44:47], v[100:103], v[136:139], v[44:47]
  ds_read_b128 v[124:127], v169 offset:6144
  v_mfma_f32_16x16x32_bf16 v[64:67], v[104:107], v[136:139], v[64:67]
  ds_read_b64_tr_b16 v[160:161], v175 offset:10240
  v_mfma_f32_16x16x32_bf16 v[84:87], v[108:111], v[136:139], v[84:87]
  ds_read_b64_tr_b16 v[162:163], v175 offset:11520
  v_mfma_f32_16x16x32_bf16 v[28:31], v[96:99], v[140:143], v[28:31]
  ds_read_b64_tr_b16 v[164:165], v176 offset:10240
  v_mfma_f32_16x16x32_bf16 v[48:51], v[100:103], v[140:143], v[48:51]
  ds_read_b64_tr_b16 v[166:167], v176 offset:11520
  v_mfma_f32_16x16x32_bf16 v[68:71], v[104:107], v[140:143], v[68:71]
  v_mfma_f32_16x16x32_bf16 v[88:91], v[108:111], v[140:143], v[88:91]
  v_mfma_f32_16x16x32_bf16 v[32:35], v[96:99], v[144:147], v[32:35]
  v_mfma_f32_16x16x32_bf16 v[52:55], v[100:103], v[144:147], v[52:55]
  v_mfma_f32_16x16x32_bf16 v[72:75], v[104:107], v[144:147], v[72:75]
  v_mfma_f32_16x16x32_bf16 v[92:95], v[108:111], v[144:147], v[92:95]
  s_waitcnt lgkmcnt(0)
  s_barrier
  v_mfma_f32_16x16x32_bf16 v[16:19], v[112:115], v[148:151], v[16:19]
  ds_read_b128 v[96:99], v168 offset:39424
  v_mfma_f32_16x16x32_bf16 v[36:39], v[116:119], v[148:151], v[36:39]
  ds_read_b64_tr_b16 v[128:129], v172 offset:39424
  v_mfma_f32_16x16x32_bf16 v[56:59], v[120:123], v[148:151], v[56:59]
  ds_read_b64_tr_b16 v[130:131], v172 offset:40704
  v_mfma_f32_16x16x32_bf16 v[76:79], v[124:127], v[148:151], v[76:79]
  ds_read_b128 v[100:103], v168 offset:41472
  v_mfma_f32_16x16x32_bf16 v[20:23], v[112:115], v[152:155], v[20:23]
  ds_read_b64_tr_b16 v[132:133], v173 offset:39424
  v_mfma_f32_16x16x32_bf16 v[40:43], v[116:119], v[152:155], v[40:43]
  ds_read_b64_tr_b16 v[134:135], v173 offset:40704
  v_mfma_f32_16x16x32_bf16 v[60:63], v[120:123], v[152:155], v[60:63]
  ds_read_b128 v[104:107], v168 offset:43520
  v_mfma_f32_16x16x32_bf16 v[80:83], v[124:127], v[152:155], v[80:83]
  ds_read_b64_tr_b16 v[136:137], v174 offset:39424
  v_mfma_f32_16x16x32_bf16 v[24:27], v[112:115], v[156:159], v[24:27]
  ds_read_b64_tr_b16 v[138:139], v174 offset:40704
  v_mfma_f32_16x16x32_bf16 v[44:47], v[116:119], v[156:159], v[44:47]
  ds_read_b128 v[108:111], v168 offset:45568
  v_mfma_f32_16x16x32_bf16 v[64:67], v[120:123], v[156:159], v[64:67]
  ds_read_b64_tr_b16 v[140:141], v175 offset:39424
  v_mfma_f32_16x16x32_bf16 v[84:87], v[124:127], v[156:159], v[84:87]
  ds_read_b64_tr_b16 v[142:143], v175 offset:40704
  v_mfma_f32_16x16x32_bf16 v[28:31], v[112:115], v[160:163], v[28:31]
  ds_read_b64_tr_b16 v[144:145], v176 offset:39424
  v_mfma_f32_16x16x32_bf16 v[48:51], v[116:119], v[160:163], v[48:51]
  ds_read_b64_tr_b16 v[146:147], v176 offset:40704
  v_mfma_f32_16x16x32_bf16 v[68:71], v[120:123], v[160:163], v[68:71]
  v_mfma_f32_16x16x32_bf16 v[88:91], v[124:127], v[160:163], v[88:91]
  v_mfma_f32_16x16x32_bf16 v[32:35], v[112:115], v[164:167], v[32:35]
  v_mfma_f32_16x16x32_bf16 v[52:55], v[116:119], v[164:167], v[52:55]
  v_mfma_f32_16x16x32_bf16 v[72:75], v[120:123], v[164:167], v[72:75]
  v_mfma_f32_16x16x32_bf16 v[92:95], v[124:127], v[164:167], v[92:95]
  s_waitcnt lgkmcnt(0)
  v_mfma_f32_16x16x32_bf16 v[16:19], v[96:99], v[128:131], v[16:19]
  ds_read_b128 v[112:115], v169 offset:39424
  v_mfma_f32_16x16x32_bf16 v[36:39], v[100:103], v[128:131], v[36:39]
  ds_read_b64_tr_b16 v[148:149], v172 offset:49664
  v_mfma_f32_16x16x32_bf16 v[56:59], v[104:107], v[128:131], v[56:59]
  ds_read_b64_tr_b16 v[150:151], v172 offset:50944
  v_mfma_f32_16x16x32_bf16 v[76:79], v[108:111], v[128:131], v[76:79]
  ds_read_b128 v[116:119], v169 offset:41472
  v_mfma_f32_16x16x32_bf16 v[20:23], v[96:99], v[132:135], v[20:23]
  ds_read_b64_tr_b16 v[152:153], v173 offset:49664
  v_mfma_f32_16x16x32_bf16 v[40:43], v[100:103], v[132:135], v[40:43]
  ds_read_b64_tr_b16 v[154:155], v173 offset:50944
  v_mfma_f32_16x16x32_bf16 v[60:63], v[104:107], v[132:135], v[60:63]
  ds_read_b128 v[120:123], v169 offset:43520
  v_mfma_f32_16x16x32_bf16 v[80:83], v[108:111], v[132:135], v[80:83]
  ds_read_b64_tr_b16 v[156:157], v174 offset:49664
  v_mfma_f32_16x16x32_bf16 v[24:27], v[96:99], v[136:139], v[24:27]
  ds_read_b64_tr_b16 v[158:159], v174 offset:50944
  v_mfma_f32_16x16x32_bf16 v[44:47], v[100:103], v[136:139], v[44:47]
  ds_read_b128 v[124:127], v169 offset:45568
  v_mfma_f32_16x16x32_bf16 v[64:67], v[104:107], v[136:139], v[64:67]
  ds_read_b64_tr_b16 v[160:161], v175 offset:49664
  v_mfma_f32_16x16x32_bf16 v[84:87], v[108:111], v[136:139], v[84:87]
  ds_read_b64_tr_b16 v[162:163], v175 offset:50944
  v_mfma_f32_16x16x32_bf16 v[28:31], v[96:99], v[140:143], v[28:31]
  ds_read_b64_tr_b16 v[164:165], v176 offset:49664
  v_mfma_f32_16x16x32_bf16 v[48:51], v[100:103], v[140:143], v[48:51]
  ds_read_b64_tr_b16 v[166:167], v176 offset:50944
  v_mfma_f32_16x16x32_bf16 v[68:71], v[104:107], v[140:143], v[68:71]
  v_mfma_f32_16x16x32_bf16 v[88:91], v[108:111], v[140:143], v[88:91]
  v_mfma_f32_16x16x32_bf16 v[32:35], v[96:99], v[144:147], v[32:35]
  v_mfma_f32_16x16x32_bf16 v[52:55], v[100:103], v[144:147], v[52:55]
  v_mfma_f32_16x16x32_bf16 v[72:75], v[104:107], v[144:147], v[72:75]
  v_mfma_f32_16x16x32_bf16 v[92:95], v[108:111], v[144:147], v[92:95]
  s_waitcnt lgkmcnt(0)
  s_barrier
  v_mfma_f32_16x16x32_bf16 v[16:19], v[112:115], v[148:151], v[16:19]
  ds_read_b128 v[96:99], v170 offset:0
  v_mfma_f32_16x16x32_bf16 v[36:39], v[116:119], v[148:151], v[36:39]
  ds_read_b64_tr_b16 v[128:129], v177 offset:0
  v_mfma_f32_16x16x32_bf16 v[56:59], v[120:123], v[148:151], v[56:59]
  ds_read_b64_tr_b16 v[130:131], v177 offset:1280
  v_mfma_f32_16x16x32_bf16 v[76:79], v[124:127], v[148:151], v[76:79]
  ds_read_b128 v[100:103], v170 offset:2048
  v_mfma_f32_16x16x32_bf16 v[20:23], v[112:115], v[152:155], v[20:23]
  ds_read_b64_tr_b16 v[132:133], v178 offset:0
  v_mfma_f32_16x16x32_bf16 v[40:43], v[116:119], v[152:155], v[40:43]
  ds_read_b64_tr_b16 v[134:135], v178 offset:1280
  v_mfma_f32_16x16x32_bf16 v[60:63], v[120:123], v[152:155], v[60:63]
  ds_read_b128 v[104:107], v170 offset:4096
  v_mfma_f32_16x16x32_bf16 v[80:83], v[124:127], v[152:155], v[80:83]
  ds_read_b64_tr_b16 v[136:137], v179 offset:0
  v_mfma_f32_16x16x32_bf16 v[24:27], v[112:115], v[156:159], v[24:27]
  ds_read_b64_tr_b16 v[138:139], v179 offset:1280
  v_mfma_f32_16x16x32_bf16 v[44:47], v[116:119], v[156:159], v[44:47]
  ds_read_b128 v[108:111], v170 offset:6144
  v_mfma_f32_16x16x32_bf16 v[64:67], v[120:123], v[156:159], v[64:67]
  ds_read_b64_tr_b16 v[140:141], v180 offset:0
  v_mfma_f32_16x16x32_bf16 v[84:87], v[124:127], v[156:159], v[84:87]
  ds_read_b64_tr_b16 v[142:143], v180 offset:1280
  v_mfma_f32_16x16x32_bf16 v[28:31], v[112:115], v[160:163], v[28:31]
  ds_read_b64_tr_b16 v[144:145], v181 offset:0
  v_mfma_f32_16x16x32_bf16 v[48:51], v[116:119], v[160:163], v[48:51]
  ds_read_b64_tr_b16 v[146:147], v181 offset:1280
  v_mfma_f32_16x16x32_bf16 v[68:71], v[120:123], v[160:163], v[68:71]
  v_mfma_f32_16x16x32_bf16 v[88:91], v[124:127], v[160:163], v[88:91]
  v_mfma_f32_16x16x32_bf16 v[32:35], v[112:115], v[164:167], v[32:35]
  v_mfma_f32_16x16x32_bf16 v[52:55], v[116:119], v[164:167], v[52:55]
  v_mfma_f32_16x16x32_bf16 v[72:75], v[120:123], v[164:167], v[72:75]
  v_mfma_f32_16x16x32_bf16 v[92:95], v[124:127], v[164:167], v[92:95]
  s_waitcnt lgkmcnt(0)
  v_mfma_f32_16x16x32_bf16 v[16:19], v[96:99], v[128:131], v[16:19]
  ds_read_b128 v[112:115], v171 offset:0
  v_mfma_f32_16x16x32_bf16 v[36:39], v[100:103], v[128:131], v[36:39]
  ds_read_b64_tr_b16 v[148:149], v177 offset:10240
  v_mfma_f32_16x16x32_bf16 v[56:59], v[104:107], v[128:131], v[56:59]
  ds_read_b64_tr_b16 v[150:151], v177 offset:11520
  v_mfma_f32_16x16x32_bf16 v[76:79], v[108:111], v[128:131], v[76:79]
  ds_read_b128 v[116:119], v171 offset:2048
  v_mfma_f32_16x16x32_bf16 v[20:23], v[96:99], v[132:135], v[20:23]
  ds_read_b64_tr_b16 v[152:153], v178 offset:10240
  v_mfma_f32_16x16x32_bf16 v[40:43], v[100:103], v[132:135], v[40:43]
  ds_read_b64_tr_b16 v[154:155], v178 offset:11520
  v_mfma_f32_16x16x32_bf16 v[60:63], v[104:107], v[132:135], v[60:63]
  ds_read_b128 v[120:123], v171 offset:4096
  v_mfma_f32_16x16x32_bf16 v[80:83], v[108:111], v[132:135], v[80:83]
  ds_read_b64_tr_b16 v[156:157], v179 offset:10240
  v_mfma_f32_16x16x32_bf16 v[24:27], v[96:99], v[136:139], v[24:27]
  ds_read_b64_tr_b16 v[158:159], v179 offset:11520
  v_mfma_f32_16x16x32_bf16 v[44:47], v[100:103], v[136:139], v[44:47]
  ds_read_b128 v[124:127], v171 offset:6144
  v_mfma_f32_16x16x32_bf16 v[64:67], v[104:107], v[136:139], v[64:67]
  ds_read_b64_tr_b16 v[160:161], v180 offset:10240
  v_mfma_f32_16x16x32_bf16 v[84:87], v[108:111], v[136:139], v[84:87]
  ds_read_b64_tr_b16 v[162:163], v180 offset:11520
  v_mfma_f32_16x16x32_bf16 v[28:31], v[96:99], v[140:143], v[28:31]
  ds_read_b64_tr_b16 v[164:165], v181 offset:10240
  v_mfma_f32_16x16x32_bf16 v[48:51], v[100:103], v[140:143], v[48:51]
  ds_read_b64_tr_b16 v[166:167], v181 offset:11520
  v_mfma_f32_16x16x32_bf16 v[68:71], v[104:107], v[140:143], v[68:71]
  v_mfma_f32_16x16x32_bf16 v[88:91], v[108:111], v[140:143], v[88:91]
  v_mfma_f32_16x16x32_bf16 v[32:35], v[96:99], v[144:147], v[32:35]
  v_mfma_f32_16x16x32_bf16 v[52:55], v[100:103], v[144:147], v[52:55]
  v_mfma_f32_16x16x32_bf16 v[72:75], v[104:107], v[144:147], v[72:75]
  v_mfma_f32_16x16x32_bf16 v[92:95], v[108:111], v[144:147], v[92:95]
  s_waitcnt lgkmcnt(0)
  s_barrier
  v_mfma_f32_16x16x32_bf16 v[16:19], v[112:115], v[148:151], v[16:19]
  ds_read_b128 v[96:99], v170 offset:39424
  v_mfma_f32_16x16x32_bf16 v[36:39], v[116:119], v[148:151], v[36:39]
  ds_read_b64_tr_b16 v[128:129], v177 offset:39424
  v_mfma_f32_16x16x32_bf16 v[56:59], v[120:123], v[148:151], v[56:59]
  ds_read_b64_tr_b16 v[130:131], v177 offset:40704
  v_mfma_f32_16x16x32_bf16 v[76:79], v[124:127], v[148:151], v[76:79]
  ds_read_b128 v[100:103], v170 offset:41472
  v_mfma_f32_16x16x32_bf16 v[20:23], v[112:115], v[152:155], v[20:23]
  ds_read_b64_tr_b16 v[132:133], v178 offset:39424
  v_mfma_f32_16x16x32_bf16 v[40:43], v[116:119], v[152:155], v[40:43]
  ds_read_b64_tr_b16 v[134:135], v178 offset:40704
  v_mfma_f32_16x16x32_bf16 v[60:63], v[120:123], v[152:155], v[60:63]
  ds_read_b128 v[104:107], v170 offset:43520
  v_mfma_f32_16x16x32_bf16 v[80:83], v[124:127], v[152:155], v[80:83]
  ds_read_b64_tr_b16 v[136:137], v179 offset:39424
  v_mfma_f32_16x16x32_bf16 v[24:27], v[112:115], v[156:159], v[24:27]
  ds_read_b64_tr_b16 v[138:139], v179 offset:40704
  v_mfma_f32_16x16x32_bf16 v[44:47], v[116:119], v[156:159], v[44:47]
  ds_read_b128 v[108:111], v170 offset:45568
  v_mfma_f32_16x16x32_bf16 v[64:67], v[120:123], v[156:159], v[64:67]
  ds_read_b64_tr_b16 v[140:141], v180 offset:39424
  v_mfma_f32_16x16x32_bf16 v[84:87], v[124:127], v[156:159], v[84:87]
  ds_read_b64_tr_b16 v[142:143], v180 offset:40704
  v_mfma_f32_16x16x32_bf16 v[28:31], v[112:115], v[160:163], v[28:31]
  ds_read_b64_tr_b16 v[144:145], v181 offset:39424
  v_mfma_f32_16x16x32_bf16 v[48:51], v[116:119], v[160:163], v[48:51]
  ds_read_b64_tr_b16 v[146:147], v181 offset:40704
  v_mfma_f32_16x16x32_bf16 v[68:71], v[120:123], v[160:163], v[68:71]
  v_mfma_f32_16x16x32_bf16 v[88:91], v[124:127], v[160:163], v[88:91]
  v_mfma_f32_16x16x32_bf16 v[32:35], v[112:115], v[164:167], v[32:35]
  v_mfma_f32_16x16x32_bf16 v[52:55], v[116:119], v[164:167], v[52:55]
  v_mfma_f32_16x16x32_bf16 v[72:75], v[120:123], v[164:167], v[72:75]
  v_mfma_f32_16x16x32_bf16 v[92:95], v[124:127], v[164:167], v[92:95]
  s_waitcnt lgkmcnt(0)
  v_mfma_f32_16x16x32_bf16 v[16:19], v[96:99], v[128:131], v[16:19]
  ds_read_b128 v[112:115], v171 offset:39424
  v_mfma_f32_16x16x32_bf16 v[36:39], v[100:103], v[128:131], v[36:39]
  ds_read_b64_tr_b16 v[148:149], v177 offset:49664
  v_mfma_f32_16x16x32_bf16 v[56:59], v[104:107], v[128:131], v[56:59]
  ds_read_b64_tr_b16 v[150:151], v177 offset:50944
  v_mfma_f32_16x16x32_bf16 v[76:79], v[108:111], v[128:131], v[76:79]
  ds_read_b128 v[116:119], v171 offset:41472
  v_mfma_f32_16x16x32_bf16 v[20:23], v[96:99], v[132:135], v[20:23]
  ds_read_b64_tr_b16 v[152:153], v178 offset:49664
  v_mfma_f32_16x16x32_bf16 v[40:43], v[100:103], v[132:135], v[40:43]
  ds_read_b64_tr_b16 v[154:155], v178 offset:50944
  v_mfma_f32_16x16x32_bf16 v[60:63], v[104:107], v[132:135], v[60:63]
  ds_read_b128 v[120:123], v171 offset:43520
  v_mfma_f32_16x16x32_bf16 v[80:83], v[108:111], v[132:135], v[80:83]
  ds_read_b64_tr_b16 v[156:157], v179 offset:49664
  v_mfma_f32_16x16x32_bf16 v[24:27], v[96:99], v[136:139], v[24:27]
  ds_read_b64_tr_b16 v[158:159], v179 offset:50944
  v_mfma_f32_16x16x32_bf16 v[44:47], v[100:103], v[136:139], v[44:47]
  ds_read_b128 v[124:127], v171 offset:45568
  v_mfma_f32_16x16x32_bf16 v[64:67], v[104:107], v[136:139], v[64:67]
  ds_read_b64_tr_b16 v[160:161], v180 offset:49664
  v_mfma_f32_16x16x32_bf16 v[84:87], v[108:111], v[136:139], v[84:87]
  ds_read_b64_tr_b16 v[162:163], v180 offset:50944
  v_mfma_f32_16x16x32_bf16 v[28:31], v[96:99], v[140:143], v[28:31]
  ds_read_b64_tr_b16 v[164:165], v181 offset:49664
  v_mfma_f32_16x16x32_bf16 v[48:51], v[100:103], v[140:143], v[48:51]
  ds_read_b64_tr_b16 v[166:167], v181 offset:50944
  v_mfma_f32_16x16x32_bf16 v[68:71], v[104:107], v[140:143], v[68:71]
  v_mfma_f32_16x16x32_bf16 v[88:91], v[108:111], v[140:143], v[88:91]
  v_mfma_f32_16x16x32_bf16 v[32:35], v[96:99], v[144:147], v[32:35]
  v_mfma_f32_16x16x32_bf16 v[52:55], v[100:103], v[144:147], v[52:55]
  v_mfma_f32_16x16x32_bf16 v[72:75], v[104:107], v[144:147], v[72:75]
  v_mfma_f32_16x16x32_bf16 v[92:95], v[108:111], v[144:147], v[92:95]
  s_waitcnt lgkmcnt(0)
  s_barrier
  v_mfma_f32_16x16x32_bf16 v[16:19], v[112:115], v[148:151], v[16:19]
  ds_read_b128 v[96:99], v168 offset:0
  v_mfma_f32_16x16x32_bf16 v[36:39], v[116:119], v[148:151], v[36:39]
  ds_read_b64_tr_b16 v[128:129], v172 offset:0
  v_mfma_f32_16x16x32_bf16 v[56:59], v[120:123], v[148:151], v[56:59]
  ds_read_b64_tr_b16 v[130:131], v172 offset:1280
  v_mfma_f32_16x16x32_bf16 v[76:79], v[124:127], v[148:151], v[76:79]
  ds_read_b128 v[100:103], v168 offset:2048
  v_mfma_f32_16x16x32_bf16 v[20:23], v[112:115], v[152:155], v[20:23]
  ds_read_b64_tr_b16 v[132:133], v173 offset:0
  v_mfma_f32_16x16x32_bf16 v[40:43], v[116:119], v[152:155], v[40:43]
  ds_read_b64_tr_b16 v[134:135], v173 offset:1280
  v_mfma_f32_16x16x32_bf16 v[60:63], v[120:123], v[152:155], v[60:63]
  ds_read_b128 v[104:107], v168 offset:4096
  v_mfma_f32_16x16x32_bf16 v[80:83], v[124:127], v[152:155], v[80:83]
  ds_read_b64_tr_b16 v[136:137], v174 offset:0
  v_mfma_f32_16x16x32_bf16 v[24:27], v[112:115], v[156:159], v[24:27]
  ds_read_b64_tr_b16 v[138:139], v174 offset:1280
  v_mfma_f32_16x16x32_bf16 v[44:47], v[116:119], v[156:159], v[44:47]
  ds_read_b128 v[108:111], v168 offset:6144
  v_mfma_f32_16x16x32_bf16 v[64:67], v[120:123], v[156:159], v[64:67]
  ds_read_b64_tr_b16 v[140:141], v175 offset:0
  v_mfma_f32_16x16x32_bf16 v[84:87], v[124:127], v[156:159], v[84:87]
  ds_read_b64_tr_b16 v[142:143], v175 offset:1280
  v_mfma_f32_16x16x32_bf16 v[28:31], v[112:115], v[160:163], v[28:31]
  ds_read_b64_tr_b16 v[144:145], v176 offset:0
  v_mfma_f32_16x16x32_bf16 v[48:51], v[116:119], v[160:163], v[48:51]
  ds_read_b64_tr_b16 v[146:147], v176 offset:1280
  v_mfma_f32_16x16x32_bf16 v[68:71], v[120:123], v[160:163], v[68:71]
  v_mfma_f32_16x16x32_bf16 v[88:91], v[124:127], v[160:163], v[88:91]
  v_mfma_f32_16x16x32_bf16 v[32:35], v[112:115], v[164:167], v[32:35]
  v_mfma_f32_16x16x32_bf16 v[52:55], v[116:119], v[164:167], v[52:55]
  v_mfma_f32_16x16x32_bf16 v[72:75], v[120:123], v[164:167], v[72:75]
  v_mfma_f32_16x16x32_bf16 v[92:95], v[124:127], v[164:167], v[92:95]
  s_waitcnt lgkmcnt(0)
  v_mfma_f32_16x16x32_bf16 v[16:19], v[96:99], v[128:131], v[16:19]
  ds_read_b128 v[112:115], v169 offset:0
  v_mfma_f32_16x16x32_bf16 v[36:39], v[100:103], v[128:131], v[36:39]
  ds_read_b64_tr_b16 v[148:149], v172 offset:10240
  v_mfma_f32_16x16x32_bf16 v[56:59], v[104:107], v[128:131], v[56:59]
  ds_read_b64_tr_b16 v[150:151], v172 offset:11520
  v_mfma_f32_16x16x32_bf16 v[76:79], v[108:111], v[128:131], v[76:79]
  ds_read_b128 v[116:119], v169 offset:2048
  v_mfma_f32_16x16x32_bf16 v[20:23], v[96:99], v[132:135], v[20:23]
  ds_read_b64_tr_b16 v[152:153], v173 offset:10240
  v_mfma_f32_16x16x32_bf16 v[40:43], v[100:103], v[132:135], v[40:43]
  ds_read_b64_tr_b16 v[154:155], v173 offset:11520
  v_mfma_f32_16x16x32_bf16 v[60:63], v[104:107], v[132:135], v[60:63]
  ds_read_b128 v[120:123], v169 offset:4096
  v_mfma_f32_16x16x32_bf16 v[80:83], v[108:111], v[132:135], v[80:83]
  ds_read_b64_tr_b16 v[156:157], v174 offset:10240
  v_mfma_f32_16x16x32_bf16 v[24:27], v[96:99], v[136:139], v[24:27]
  ds_read_b64_tr_b16 v[158:159], v174 offset:11520
  v_mfma_f32_16x16x32_bf16 v[44:47], v[100:103], v[136:139], v[44:47]
  ds_read_b128 v[124:127], v169 offset:6144
  v_mfma_f32_16x16x32_bf16 v[64:67], v[104:107], v[136:139], v[64:67]
  ds_read_b64_tr_b16 v[160:161], v175 offset:10240
  v_mfma_f32_16x16x32_bf16 v[84:87], v[108:111], v[136:139], v[84:87]
  ds_read_b64_tr_b16 v[162:163], v175 offset:11520
  v_mfma_f32_16x16x32_bf16 v[28:31], v[96:99], v[140:143], v[28:31]
  ds_read_b64_tr_b16 v[164:165], v176 offset:10240
  v_mfma_f32_16x16x32_bf16 v[48:51], v[100:103], v[140:143], v[48:51]
  ds_read_b64_tr_b16 v[166:167], v176 offset:11520
  v_mfma_f32_16x16x32_bf16 v[68:71], v[104:107], v[140:143], v[68:71]
  v_mfma_f32_16x16x32_bf16 v[88:91], v[108:111], v[140:143], v[88:91]
  v_mfma_f32_16x16x32_bf16 v[32:35], v[96:99], v[144:147], v[32:35]
  v_mfma_f32_16x16x32_bf16 v[52:55], v[100:103], v[144:147], v[52:55]
  v_mfma_f32_16x16x32_bf16 v[72:75], v[104:107], v[144:147], v[72:75]
  v_mfma_f32_16x16x32_bf16 v[92:95], v[108:111], v[144:147], v[92:95]
  s_waitcnt lgkmcnt(0)
  s_barrier
  v_mfma_f32_16x16x32_bf16 v[16:19], v[112:115], v[148:151], v[16:19]
  ds_read_b128 v[96:99], v168 offset:39424
  v_mfma_f32_16x16x32_bf16 v[36:39], v[116:119], v[148:151], v[36:39]
  ds_read_b64_tr_b16 v[128:129], v172 offset:39424
  v_mfma_f32_16x16x32_bf16 v[56:59], v[120:123], v[148:151], v[56:59]
  ds_read_b64_tr_b16 v[130:131], v172 offset:40704
  v_mfma_f32_16x16x32_bf16 v[76:79], v[124:127], v[148:151], v[76:79]
  ds_read_b128 v[100:103], v168 offset:41472
  v_mfma_f32_16x16x32_bf16 v[20:23], v[112:115], v[152:155], v[20:23]
  ds_read_b64_tr_b16 v[132:133], v173 offset:39424
  v_mfma_f32_16x16x32_bf16 v[40:43], v[116:119], v[152:155], v[40:43]
  ds_read_b64_tr_b16 v[134:135], v173 offset:40704
  v_mfma_f32_16x16x32_bf16 v[60:63], v[120:123], v[152:155], v[60:63]
  ds_read_b128 v[104:107], v168 offset:43520
  v_mfma_f32_16x16x32_bf16 v[80:83], v[124:127], v[152:155], v[80:83]
  ds_read_b64_tr_b16 v[136:137], v174 offset:39424
  v_mfma_f32_16x16x32_bf16 v[24:27], v[112:115], v[156:159], v[24:27]
  ds_read_b64_tr_b16 v[138:139], v174 offset:40704
  v_mfma_f32_16x16x32_bf16 v[44:47], v[116:119], v[156:159], v[44:47]
  ds_read_b128 v[108:111], v168 offset:45568
  v_mfma_f32_16x16x32_bf16 v[64:67], v[120:123], v[156:159], v[64:67]
  ds_read_b64_tr_b16 v[140:141], v175 offset:39424
  v_mfma_f32_16x16x32_bf16 v[84:87], v[124:127], v[156:159], v[84:87]
  ds_read_b64_tr_b16 v[142:143], v175 offset:40704
  v_mfma_f32_16x16x32_bf16 v[28:31], v[112:115], v[160:163], v[28:31]
  ds_read_b64_tr_b16 v[144:145], v176 offset:39424
  v_mfma_f32_16x16x32_bf16 v[48:51], v[116:119], v[160:163], v[48:51]
  ds_read_b64_tr_b16 v[146:147], v176 offset:40704
  v_mfma_f32_16x16x32_bf16 v[68:71], v[120:123], v[160:163], v[68:71]
  v_mfma_f32_16x16x32_bf16 v[88:91], v[124:127], v[160:163], v[88:91]
  v_mfma_f32_16x16x32_bf16 v[32:35], v[112:115], v[164:167], v[32:35]
  v_mfma_f32_16x16x32_bf16 v[52:55], v[116:119], v[164:167], v[52:55]
  v_mfma_f32_16x16x32_bf16 v[72:75], v[120:123], v[164:167], v[72:75]
  v_mfma_f32_16x16x32_bf16 v[92:95], v[124:127], v[164:167], v[92:95]
  s_waitcnt lgkmcnt(0)
  v_mfma_f32_16x16x32_bf16 v[16:19], v[96:99], v[128:131], v[16:19]
  ds_read_b128 v[112:115], v169 offset:39424
  v_mfma_f32_16x16x32_bf16 v[36:39], v[100:103], v[128:131], v[36:39]
  ds_read_b64_tr_b16 v[148:149], v172 offset:49664
  v_mfma_f32_16x16x32_bf16 v[56:59], v[104:107], v[128:131], v[56:59]
  ds_read_b64_tr_b16 v[150:151], v172 offset:50944
  v_mfma_f32_16x16x32_bf16 v[76:79], v[108:111], v[128:131], v[76:79]
  ds_read_b128 v[116:119], v169 offset:41472
  v_mfma_f32_16x16x32_bf16 v[20:23], v[96:99], v[132:135], v[20:23]
  ds_read_b64_tr_b16 v[152:153], v173 offset:49664
  v_mfma_f32_16x16x32_bf16 v[40:43], v[100:103], v[132:135], v[40:43]
  ds_read_b64_tr_b16 v[154:155], v173 offset:50944
  v_mfma_f32_16x16x32_bf16 v[60:63], v[104:107], v[132:135], v[60:63]
  ds_read_b128 v[120:123], v169 offset:43520
  v_mfma_f32_16x16x32_bf16 v[80:83], v[108:111], v[132:135], v[80:83]
  ds_read_b64_tr_b16 v[156:157], v174 offset:49664
  v_mfma_f32_16x16x32_bf16 v[24:27], v[96:99], v[136:139], v[24:27]
  ds_read_b64_tr_b16 v[158:159], v174 offset:50944
  v_mfma_f32_16x16x32_bf16 v[44:47], v[100:103], v[136:139], v[44:47]
  ds_read_b128 v[124:127], v169 offset:45568
  v_mfma_f32_16x16x32_bf16 v[64:67], v[104:107], v[136:139], v[64:67]
  ds_read_b64_tr_b16 v[160:161], v175 offset:49664
  v_mfma_f32_16x16x32_bf16 v[84:87], v[108:111], v[136:139], v[84:87]
  ds_read_b64_tr_b16 v[162:163], v175 offset:50944
  v_mfma_f32_16x16x32_bf16 v[28:31], v[96:99], v[140:143], v[28:31]
  ds_read_b64_tr_b16 v[164:165], v176 offset:49664
  v_mfma_f32_16x16x32_bf16 v[48:51], v[100:103], v[140:143], v[48:51]
  ds_read_b64_tr_b16 v[166:167], v176 offset:50944
  v_mfma_f32_16x16x32_bf16 v[68:71], v[104:107], v[140:143], v[68:71]
  v_mfma_f32_16x16x32_bf16 v[88:91], v[108:111], v[140:143], v[88:91]
  v_mfma_f32_16x16x32_bf16 v[32:35], v[96:99], v[144:147], v[32:35]
  v_mfma_f32_16x16x32_bf16 v[52:55], v[100:103], v[144:147], v[52:55]
  v_mfma_f32_16x16x32_bf16 v[72:75], v[104:107], v[144:147], v[72:75]
  v_mfma_f32_16x16x32_bf16 v[92:95], v[108:111], v[144:147], v[92:95]
  s_waitcnt lgkmcnt(0)
  v_mfma_f32_16x16x32_bf16 v[16:19], v[112:115], v[148:151], v[16:19]
  v_mfma_f32_16x16x32_bf16 v[36:39], v[116:119], v[148:151], v[36:39]
  v_mfma_f32_16x16x32_bf16 v[56:59], v[120:123], v[148:151], v[56:59]
  v_mfma_f32_16x16x32_bf16 v[76:79], v[124:127], v[148:151], v[76:79]
  v_mfma_f32_16x16x32_bf16 v[20:23], v[112:115], v[152:155], v[20:23]
  v_mfma_f32_16x16x32_bf16 v[40:43], v[116:119], v[152:155], v[40:43]
  v_mfma_f32_16x16x32_bf16 v[60:63], v[120:123], v[152:155], v[60:63]
  v_mfma_f32_16x16x32_bf16 v[80:83], v[124:127], v[152:155], v[80:83]
  v_mfma_f32_16x16x32_bf16 v[24:27], v[112:115], v[156:159], v[24:27]
  v_mfma_f32_16x16x32_bf16 v[44:47], v[116:119], v[156:159], v[44:47]
  v_mfma_f32_16x16x32_bf16 v[64:67], v[120:123], v[156:159], v[64:67]
  v_mfma_f32_16x16x32_bf16 v[84:87], v[124:127], v[156:159], v[84:87]
  v_mfma_f32_16x16x32_bf16 v[28:31], v[112:115], v[160:163], v[28:31]
  v_mfma_f32_16x16x32_bf16 v[48:51], v[116:119], v[160:163], v[48:51]
  v_mfma_f32_16x16x32_bf16 v[68:71], v[120:123], v[160:163], v[68:71]
  v_mfma_f32_16x16x32_bf16 v[88:91], v[124:127], v[160:163], v[88:91]
  v_mfma_f32_16x16x32_bf16 v[32:35], v[112:115], v[164:167], v[32:35]
  v_mfma_f32_16x16x32_bf16 v[52:55], v[116:119], v[164:167], v[52:55]
  v_mfma_f32_16x16x32_bf16 v[72:75], v[120:123], v[164:167], v[72:75]
  v_mfma_f32_16x16x32_bf16 v[92:95], v[124:127], v[164:167], v[92:95]
  s_nop 7
  v_cvt_pk_bf16_f32 v16, v16, v17
  v_cvt_pk_bf16_f32 v17, v18, v19
  v_cvt_pk_bf16_f32 v18, v36, v37
  v_cvt_pk_bf16_f32 v19, v38, v39
  v_cvt_pk_bf16_f32 v56, v56, v57
  v_cvt_pk_bf16_f32 v57, v58, v59
  v_cvt_pk_bf16_f32 v58, v76, v77
  v_cvt_pk_bf16_f32 v59, v78, v79
  s_mul_i32 s33, s43, 0
  s_add_u32 s33, s33, s44
  v_permlane16_swap_b32 v16, v18
  v_permlane16_swap_b32 v17, v19
  buffer_store_dwordx4 v[16:19], v182, s[16:19], s33 offen offset:0 sc1
  v_permlane16_swap_b32 v56, v58
  v_permlane16_swap_b32 v57, v59
  buffer_store_dwordx4 v[56:59], v182, s[16:19], s33 offen offset:1280 sc1
  v_cvt_pk_bf16_f32 v20, v20, v21
  v_cvt_pk_bf16_f32 v21, v22, v23
  v_cvt_pk_bf16_f32 v22, v40, v41
  v_cvt_pk_bf16_f32 v23, v42, v43
  v_cvt_pk_bf16_f32 v60, v60, v61
  v_cvt_pk_bf16_f32 v61, v62, v63
  v_cvt_pk_bf16_f32 v62, v80, v81
  v_cvt_pk_bf16_f32 v63, v82, v83
  s_mul_i32 s33, s43, 1
  s_add_u32 s33, s33, s44
  v_permlane16_swap_b32 v20, v22
  v_permlane16_swap_b32 v21, v23
  buffer_store_dwordx4 v[20:23], v182, s[16:19], s33 offen offset:0 sc1
  v_permlane16_swap_b32 v60, v62
  v_permlane16_swap_b32 v61, v63
  buffer_store_dwordx4 v[60:63], v182, s[16:19], s33 offen offset:1280 sc1
  v_cvt_pk_bf16_f32 v24, v24, v25
  v_cvt_pk_bf16_f32 v25, v26, v27
  v_cvt_pk_bf16_f32 v26, v44, v45
  v_cvt_pk_bf16_f32 v27, v46, v47
  v_cvt_pk_bf16_f32 v64, v64, v65
  v_cvt_pk_bf16_f32 v65, v66, v67
  v_cvt_pk_bf16_f32 v66, v84, v85
  v_cvt_pk_bf16_f32 v67, v86, v87
  s_mul_i32 s33, s43, 2
  s_add_u32 s33, s33, s44
  v_permlane16_swap_b32 v24, v26
  v_permlane16_swap_b32 v25, v27
  buffer_store_dwordx4 v[24:27], v182, s[16:19], s33 offen offset:0 sc1
  v_permlane16_swap_b32 v64, v66
  v_permlane16_swap_b32 v65, v67
  buffer_store_dwordx4 v[64:67], v182, s[16:19], s33 offen offset:1280 sc1
  v_cvt_pk_bf16_f32 v28, v28, v29
  v_cvt_pk_bf16_f32 v29, v30, v31
  v_cvt_pk_bf16_f32 v30, v48, v49
  v_cvt_pk_bf16_f32 v31, v50, v51
  v_cvt_pk_bf16_f32 v68, v68, v69
  v_cvt_pk_bf16_f32 v69, v70, v71
  v_cvt_pk_bf16_f32 v70, v88, v89
  v_cvt_pk_bf16_f32 v71, v90, v91
  s_mul_i32 s33, s43, 3
  s_add_u32 s33, s33, s44
  v_permlane16_swap_b32 v28, v30
  v_permlane16_swap_b32 v29, v31
  buffer_store_dwordx4 v[28:31], v182, s[16:19], s33 offen offset:0 sc1
  v_permlane16_swap_b32 v68, v70
  v_permlane16_swap_b32 v69, v71
  buffer_store_dwordx4 v[68:71], v182, s[16:19], s33 offen offset:1280 sc1
  v_cvt_pk_bf16_f32 v32, v32, v33
  v_cvt_pk_bf16_f32 v33, v34, v35
  v_cvt_pk_bf16_f32 v34, v52, v53
  v_cvt_pk_bf16_f32 v35, v54, v55
  v_cvt_pk_bf16_f32 v72, v72, v73
  v_cvt_pk_bf16_f32 v73, v74, v75
  v_cvt_pk_bf16_f32 v74, v92, v93
  v_cvt_pk_bf16_f32 v75, v94, v95
  s_mov_b32 s33, s44
  s_nop 0
  v_permlane16_swap_b32 v32, v34
  v_permlane16_swap_b32 v33, v35
  buffer_store_dwordx4 v[32:35], v183, s[16:19], s33 offen offset:0 sc1
  v_permlane16_swap_b32 v72, v74
  v_permlane16_swap_b32 v73, v75
  buffer_store_dwordx4 v[72:75], v183, s[16:19], s33 offen offset:1280 sc1
  s_endpgm
L_proj_kernel_end:
  s_endpgm
.text
.globl attn_kernel
.p2align 8
.type attn_kernel,@function
attn_kernel:
  s_cmp_ge_u32 s2, 256
  s_cbranch_scc1 L_attn_kernel_end
  s_load_dwordx2 s[20:21], s[0:1], 80
  s_load_dwordx2 s[84:85], s[0:1], 32
  s_load_dwordx2 s[86:87], s[0:1], 56
  v_lshrrev_b32 v5, 6, v0
  v_and_b32 v6, 63, v0
  v_readfirstlane_b32 s22, v5
  s_and_b32 s32, s2, 7
  s_lshr_b32 s33, s2, 3
  s_and_b32 s34, s33, 3
  s_lshr_b32 s35, s33, 2
  s_and_b32 s36, s35, 1
  s_lshr_b32 s37, s35, 1
  s_lshl_b32 s38, s32, 2
  s_add_u32 s38, s38, s37
  s_add_u32 s39, s38, 1
  s_mul_i32 s39, s39, s36
  s_mul_i32 s39, s39, 163840
  s_lshl_b32 s40, s36, 5
  s_add_u32 s40, s40, s38
  s_lshl_b32 s41, s34, 3
  s_add_u32 s41, s41, s22
  s_mul_i32 s42, s40, 81920
  s_mul_i32 s43, s41, 2560
  s_add_u32 s42, s42, s43
  s_add_u32 s42, s42, 5406720
  s_lshl_b32 s43, s40, 16
  s_lshl_b32 s44, s41, 11
  s_add_u32 s43, s43, s44
  s_add_u32 s43, s43, 12288000
  s_lshl_b32 s45, s40, 14
  s_lshl_b32 s46, s41, 9
  s_add_u32 s45, s45, s46
  s_add_u32 s45, s45, 16482304
  v_lshlrev_b32 v0, 4, v6
  v_and_b32 v7, 31, v6
  v_lshrrev_b32 v8, 5, v6
  v_lshlrev_b32 v9, 3, v7
  s_lshl_b32 s25, s22, 10
  s_waitcnt lgkmcnt(0)
  s_add_u32 s4, s20, s39
  s_addc_u32 s5, s21, 0
  s_and_b32 s5, s5, 0xffff
  s_mov_b32 s6, 163840
  s_mov_b32 s7, 0x20000
  s_add_u32 s8, s20, s42
  s_addc_u32 s9, s21, 0
  s_and_b32 s9, s9, 0xffff
  s_mov_b32 s10, 2560
  s_mov_b32 s11, 0x20000
  s_mov_b32 m0, s25
  s_nop 0
  buffer_load_dwordx4 v0, s[4:7], s25 offen lds
  s_add_u32 s25, s25, 8192
  buffer_load_dwordx4 v[144:147], v0, s[8:11], 0 offen offset:0
  buffer_load_dwordx2 v[152:153], v9, s[8:11], 0 offen offset:1024
  buffer_load_dwordx4 v[148:151], v0, s[8:11], 0 offen offset:1280
  buffer_load_dwordx2 v[154:155], v9, s[8:11], 0 offen offset:2304
  s_mov_b32 m0, s25
  s_nop 0
  buffer_load_dwordx4 v0, s[4:7], s25 offen lds
  s_add_u32 s25, s25, 8192
  s_add_u32 s12, s20, s42
  s_addc_u32 s13, s21, 0
  s_and_b32 s13, s13, 0xffff
  s_mov_b32 s14, 2560
  s_mov_b32 s15, 0x20000
  s_add_u32 s16, s20, s42
  s_addc_u32 s17, s21, 0
  s_and_b32 s17, s17, 0xffff
  s_mov_b32 s18, 2560
  s_mov_b32 s19, 0x20000
  s_lshl_b32 s68, s2, 3
  s_add_u32 s68, s68, s22
  s_cmp_lt_u32 s68, 1600
  s_cselect_b32 s80, 1, 0
  s_min_u32 s68, s68, 1599
  s_cmp_ge_u32 s68, 800
  s_cselect_b32 s69, 800, 0
  s_cselect_b32 s76, s86, s84
  s_cselect_b32 s77, s87, s85
  s_sub_u32 s69, s68, s69
  s_mul_hi_u32 s70, s69, 858993460
  s_mul_i32 s71, s70, 5
  s_sub_u32 s71, s69, s71
  s_mul_hi_u32 s72, s70, 214748365
  s_mul_i32 s73, s72, 20
  s_sub_u32 s73, s70, s73
  s_and_b32 s77, s77, 0xffff
  s_mov_b32 s78, 819200
  s_mov_b32 s79, 0x20000
  s_mul_i32 s72, s72, 160
  s_lshl_b32 s71, s71, 5
  s_add_u32 s72, s72, s71
  v_and_b32 v11, 15, v6
  v_lshrrev_b32 v12, 4, v6
  v_lshrrev_b32 v13, 1, v12
  v_and_b32 v12, 1, v12
  v_lshlrev_b32 v11, 1, v11
  v_add_u32 v11, s72, v11
  s_lshl_b32 s74, s73, 1
  s_cmp_lt_u32 s73, 16
  s_cbranch_scc0 L_attn_kernel_woq
  v_add_u32 v13, s74, v13
  v_mul_u32_u24 v13, 20, v13
  v_lshl_add_u32 v13, v12, 3, v13
  s_movk_i32 s75, 5120
  s_branch L_attn_kernel_wol
L_attn_kernel_woq:
  s_sub_u32 s74, s74, 32
  v_add_u32 v13, s74, v13
  v_mul_u32_u24 v13, 80, v13
  v_mul_u32_u24 v12, 40, v12
  v_add3_u32 v13, v13, v12, 16
  s_movk_i32 s75, 25600
L_attn_kernel_wol:
  v_mul_u32_u24 v13, 1280, v13
  v_add_u32 v221, v11, v13
  v_lshlrev_b32 v223, 5, v7
  v_lshl_add_u32 v222, v8, 4, v223
  v_lshlrev_b32 v223, 3, v7
  v_lshlrev_b32 v208, 3, v6
  v_add_u32 v208, 2048, v208
  v_lshlrev_b32 v11, 3, v8
  v_add_u32 v11, v11, v7
  v_and_b32 v11, 15, v11
  v_lshl_add_u32 v11, v8, 4, v11
  v_and_b32 v12, 3, v7
  v_lshl_add_u32 v12, v8, 2, v12
  v_cmp_gt_u32 vcc, 16, v7
  v_add_u32 v12, 32, v12
  s_nop 0
  v_cndmask_b32 v11, v12, v11, vcc
  v_lshlrev_b32 v209, 4, v11
  v_add_u32 v209, 2560, v209
  s_mov_b32 s30, 0x000fffff
  s_mov_b32 s31, 0x000fffff
  v_mov_b32 v4, 0xdddddddd
  v_cmp_eq_u32 vcc, 20, v7
  v_mov_b32 v10, 0x3f803f80
  s_nop 0
  v_cndmask_b32 v10, 0, v10, vcc
  v_mov_b32 v176, v10
  v_mov_b32 v177, v10
  v_mov_b32 v178, v10
  v_mov_b32 v179, v10
  v_mov_b32 v180, v10
  v_mov_b32 v181, v10
  v_mov_b32 v182, v10
  v_mov_b32 v183, v10
  v_mov_b32 v184, v10
  v_mov_b32 v185, v10
  v_mov_b32 v186, v10
  v_mov_b32 v187, v10
  v_mov_b32 v188, v10
  v_mov_b32 v189, v10
  v_mov_b32 v190, v10
  v_mov_b32 v191, v10
  v_mov_b32 v192, v10
  v_mov_b32 v193, v10
  v_mov_b32 v194, v10
  v_mov_b32 v195, v10
  v_mov_b32 v196, v10
  v_mov_b32 v197, v10
  v_mov_b32 v198, v10
  v_mov_b32 v199, v10
  v_mov_b32 v200, v10
  v_mov_b32 v201, v10
  v_mov_b32 v202, v10
  v_mov_b32 v203, v10
  v_mov_b32 v204, v10
  v_mov_b32 v205, v10
  v_mov_b32 v206, v10
  v_mov_b32 v207, v10
  s_cmp_lt_u32 s22, 4
  s_cselect_b32 s26, 34, 0
  s_cselect_b32 s27, 0, 34
  s_mov_b32 s28, 0
L_attn_kernel_run:
  v_mov_b32 v12, 0
  v_mov_b32 v13, 0
  v_mov_b32 v14, 0
  v_mov_b32 v15, 0
  s_mov_b32 s24, 0
  s_nop 0
  v_mfma_f32_32x32x16_bf16 v[80:95], v[12:15], v[12:15], 0
  v_mfma_f32_32x32x16_bf16 v[96:111], v[12:15], v[12:15], 0
  v_mfma_f32_32x32x16_bf16 v[48:63], v[12:15], v[12:15], 0
  v_mfma_f32_32x32x16_bf16 v[64:79], v[12:15], v[12:15], 0
  v_add_u32 v1, s24, v0
  v_add_u32 v2, s24, v208
  v_add_u32 v3, s24, v209
  s_cmp_lg_u32 s28, 0
  s_cbranch_scc1 L_attn_kernel_run2
  s_waitcnt vmcnt(0)
  s_barrier
  s_mov_b32 m0, s25
  s_nop 0
  buffer_load_dwordx4 v0, s[4:7], s25 offen lds
  s_add_u32 s25, s25, 8192
  s_mov_b32 m0, s25
  s_nop 0
  buffer_load_dwordx4 v0, s[4:7], s25 offen lds
  s_add_u32 s25, s25, 8192
  s_cmp_eq_u32 s80, 0
  s_cbranch_scc1 L_attn_kernel_nowol
  buffer_load_ushort v212, v221, s[76:79], 0 offen offset:0
  buffer_load_ushort v216, v221, s[76:79], 0 offen offset:1280
  buffer_load_ushort v213, v221, s[76:79], 0 offen offset:2560
  buffer_load_ushort v217, v221, s[76:79], 0 offen offset:3840
  buffer_load_ushort v214, v221, s[76:79], s75 offen offset:0
  buffer_load_ushort v218, v221, s[76:79], s75 offen offset:1280
  buffer_load_ushort v215, v221, s[76:79], s75 offen offset:2560
  buffer_load_ushort v219, v221, s[76:79], s75 offen offset:3840
L_attn_kernel_nowol:
L_attn_kernel_run2:
  ds_read_b128 v[156:159], v1 offset:0
  ds_read_b128 v[160:163], v1 offset:1024
  ds_read_b64 v[164:165], v2 offset:0
  s_mov_b64 exec, s[30:31]
  ds_read_b128 v[176:179], v3 offset:0
  ds_read_b128 v[180:183], v3 offset:640
  ds_read_b128 v[184:187], v3 offset:1280
  ds_read_b128 v[188:191], v3 offset:1920
  s_mov_b64 exec, -1
  s_mov_b32 s23, 0
  s_waitcnt lgkmcnt(0)
  s_cmp_lg_u32 s28, 0
  s_cbranch_scc1 L_attn_kernel_entryC
  s_branch L_attn_kernel_entryA
.p2align 6
L_attn_kernel_loopA:
  s_bitcmp1_b32 s27, s23
  s_cbranch_scc1 L_attn_kernel_baryA
L_attn_kernel_barbyA:
  v_exp_f32 v48, v48
  v_exp_f32 v49, v49
  v_exp_f32 v50, v50
  v_exp_f32 v51, v51
  v_exp_f32 v52, v52
  v_exp_f32 v53, v53
  v_exp_f32 v54, v54
  v_exp_f32 v55, v55
  s_setprio 1
  v_exp_f32 v56, v56
  v_exp_f32 v57, v57
  v_exp_f32 v58, v58
  v_exp_f32 v59, v59
  v_exp_f32 v60, v60
  v_exp_f32 v61, v61
  v_exp_f32 v62, v62
  v_exp_f32 v63, v63
  v_exp_f32 v64, v64
  v_exp_f32 v65, v65
  v_exp_f32 v66, v66
  v_exp_f32 v67, v67
  v_exp_f32 v68, v68
  v_exp_f32 v69, v69
  v_exp_f32 v70, v70
  v_exp_f32 v71, v71
  v_exp_f32 v72, v72
  v_exp_f32 v73, v73
  v_exp_f32 v74, v74
  v_exp_f32 v75, v75
  v_exp_f32 v76, v76
  v_exp_f32 v77, v77
  v_exp_f32 v78, v78
  v_exp_f32 v79, v79
L_attn_kernel_entryA:
  s_bitcmp1_b32 s26, s23
  s_cbranch_scc1 L_attn_kernel_barxA
L_attn_kernel_barbxA:
  s_waitcnt lgkmcnt(0)
  s_setprio 3
  v_mfma_f32_32x32x16_bf16 v[16:31], v[156:159], v[144:147], 0
  ds_read_b128 v[166:169], v1 offset:5120
  v_mfma_f32_32x32x16_bf16 v[32:47], v[160:163], v[144:147], 0
  ds_read_b128 v[170:173], v1 offset:6144
  v_smfmac_f32_32x32x32_bf16 v[96:111], v[192:195], v[48:55], v4
  ds_read_b64 v[174:175], v2 offset:5120
  v_mfma_f32_32x32x4_2b_bf16 v[16:47], v[164:165], v[152:153], v[16:47]
  s_mov_b32 m0, s25
  s_nop 0
  buffer_load_dwordx4 v0, s[4:7], s25 offen lds
  s_add_u32 s25, s25, 8192
  v_smfmac_f32_32x32x32_bf16 v[96:111], v[196:199], v[56:63], v4
  v_smfmac_f32_32x32x32_bf16 v[96:111], v[200:203], v[64:71], v4
  v_smfmac_f32_32x32x32_bf16 v[96:111], v[204:207], v[72:79], v4
  s_setprio 0
  v_exp_f32 v16, v16
  v_exp_f32 v17, v17
  v_exp_f32 v18, v18
  v_exp_f32 v19, v19
  v_exp_f32 v20, v20
  v_exp_f32 v21, v21
  v_exp_f32 v22, v22
  v_exp_f32 v23, v23
  s_setprio 1
  v_exp_f32 v24, v24
  v_exp_f32 v25, v25
  v_exp_f32 v26, v26
  v_exp_f32 v27, v27
  v_exp_f32 v28, v28
  v_exp_f32 v29, v29
  v_exp_f32 v30, v30
  v_exp_f32 v31, v31
  v_exp_f32 v32, v32
  v_exp_f32 v33, v33
  v_exp_f32 v34, v34
  v_exp_f32 v35, v35
  v_exp_f32 v36, v36
  v_exp_f32 v37, v37
  v_exp_f32 v38, v38
  v_exp_f32 v39, v39
  v_exp_f32 v40, v40
  v_exp_f32 v41, v41
  v_exp_f32 v42, v42
  v_exp_f32 v43, v43
  v_exp_f32 v44, v44
  v_exp_f32 v45, v45
  v_exp_f32 v46, v46
  v_exp_f32 v47, v47
  s_setprio 3
  v_mfma_f32_32x32x16_bf16 v[48:63], v[156:159], v[148:151], 0
  v_mfma_f32_32x32x16_bf16 v[64:79], v[160:163], v[148:151], 0
  v_smfmac_f32_32x32x32_bf16 v[80:95], v[176:179], v[16:23], v4
  v_mfma_f32_32x32x4_2b_bf16 v[48:79], v[164:165], v[154:155], v[48:79]
  s_mov_b64 exec, s[30:31]
  ds_read_b128 v[192:195], v3 offset:5120
  ds_read_b128 v[196:199], v3 offset:5760
  ds_read_b128 v[200:203], v3 offset:6400
  ds_read_b128 v[204:207], v3 offset:7040
  s_mov_b64 exec, -1
  v_smfmac_f32_32x32x32_bf16 v[80:95], v[180:183], v[24:31], v4
  s_mov_b32 m0, s25
  s_nop 0
  buffer_load_dwordx4 v0, s[4:7], s25 offen lds
  s_add_u32 s25, s25, 8192
  v_smfmac_f32_32x32x32_bf16 v[80:95], v[184:187], v[32:39], v4
  v_smfmac_f32_32x32x32_bf16 v[80:95], v[188:191], v[40:47], v4
  s_add_u32 s24, s24, 10240
  s_cmp_eq_u32 s24, 163840
  s_cselect_b32 s24, 0, s24
  v_add_u32 v1, s24, v0
  v_add_u32 v2, s24, v208
  v_add_u32 v3, s24, v209
  s_setprio 0
  v_exp_f32 v48, v48
  v_exp_f32 v49, v49
  v_exp_f32 v50, v50
  v_exp_f32 v51, v51
  v_exp_f32 v52, v52
  v_exp_f32 v53, v53
  v_exp_f32 v54, v54
  v_exp_f32 v55, v55
  s_setprio 1
  v_exp_f32 v56, v56
  v_exp_f32 v57, v57
  v_exp_f32 v58, v58
  v_exp_f32 v59, v59
  v_exp_f32 v60, v60
  v_exp_f32 v61, v61
  v_exp_f32 v62, v62
  v_exp_f32 v63, v63
  v_exp_f32 v64, v64
  v_exp_f32 v65, v65
  v_exp_f32 v66, v66
  v_exp_f32 v67, v67
  v_exp_f32 v68, v68
  v_exp_f32 v69, v69
  v_exp_f32 v70, v70
  v_exp_f32 v71, v71
  v_exp_f32 v72, v72
  v_exp_f32 v73, v73
  v_exp_f32 v74, v74
  v_exp_f32 v75, v75
  v_exp_f32 v76, v76
  v_exp_f32 v77, v77
  v_exp_f32 v78, v78
  v_exp_f32 v79, v79
  s_waitcnt lgkmcnt(0)
  s_setprio 3
  v_mfma_f32_32x32x16_bf16 v[16:31], v[166:169], v[144:147], 0
  ds_read_b128 v[156:159], v1 offset:0
  v_mfma_f32_32x32x16_bf16 v[32:47], v[170:173], v[144:147], 0
  ds_read_b128 v[160:163], v1 offset:1024
  v_smfmac_f32_32x32x32_bf16 v[96:111], v[176:179], v[48:55], v4
  ds_read_b64 v[164:165], v2 offset:0
  v_mfma_f32_32x32x4_2b_bf16 v[16:47], v[174:175], v[152:153], v[16:47]
  s_mov_b32 m0, s25
  s_nop 0
  buffer_load_dwordx4 v0, s[4:7], s25 offen lds
  s_add_u32 s25, s25, 8192
  v_smfmac_f32_32x32x32_bf16 v[96:111], v[180:183], v[56:63], v4
  v_smfmac_f32_32x32x32_bf16 v[96:111], v[184:187], v[64:71], v4
  v_smfmac_f32_32x32x32_bf16 v[96:111], v[188:191], v[72:79], v4
  s_setprio 0
  v_exp_f32 v16, v16
  v_exp_f32 v17, v17
  v_exp_f32 v18, v18
  v_exp_f32 v19, v19
  v_exp_f32 v20, v20
  v_exp_f32 v21, v21
  v_exp_f32 v22, v22
  v_exp_f32 v23, v23
  s_setprio 1
  v_exp_f32 v24, v24
  v_exp_f32 v25, v25
  v_exp_f32 v26, v26
  v_exp_f32 v27, v27
  v_exp_f32 v28, v28
  v_exp_f32 v29, v29
  v_exp_f32 v30, v30
  v_exp_f32 v31, v31
  v_exp_f32 v32, v32
  v_exp_f32 v33, v33
  v_exp_f32 v34, v34
  v_exp_f32 v35, v35
  v_exp_f32 v36, v36
  v_exp_f32 v37, v37
  v_exp_f32 v38, v38
  v_exp_f32 v39, v39
  v_exp_f32 v40, v40
  v_exp_f32 v41, v41
  v_exp_f32 v42, v42
  v_exp_f32 v43, v43
  v_exp_f32 v44, v44
  v_exp_f32 v45, v45
  v_exp_f32 v46, v46
  v_exp_f32 v47, v47
  s_setprio 3
  v_mfma_f32_32x32x16_bf16 v[48:63], v[166:169], v[148:151], 0
  v_mfma_f32_32x32x16_bf16 v[64:79], v[170:173], v[148:151], 0
  v_smfmac_f32_32x32x32_bf16 v[80:95], v[192:195], v[16:23], v4
  v_mfma_f32_32x32x4_2b_bf16 v[48:79], v[174:175], v[154:155], v[48:79]
  s_mov_b64 exec, s[30:31]
  ds_read_b128 v[176:179], v3 offset:0
  ds_read_b128 v[180:183], v3 offset:640
  ds_read_b128 v[184:187], v3 offset:1280
  ds_read_b128 v[188:191], v3 offset:1920
  s_mov_b64 exec, -1
  v_smfmac_f32_32x32x32_bf16 v[80:95], v[196:199], v[24:31], v4
  s_mov_b32 m0, s25
  s_nop 0
  buffer_load_dwordx4 v0, s[4:7], s25 offen lds
  s_add_u32 s25, s25, 8192
  v_smfmac_f32_32x32x32_bf16 v[80:95], v[200:203], v[32:39], v4
  s_add_u32 s23, s23, 1
  v_smfmac_f32_32x32x32_bf16 v[80:95], v[204:207], v[40:47], v4
  s_cmp_lt_u32 s23, 4
  s_setprio 0
  s_cbranch_scc1 L_attn_kernel_loopA
.p2align 6
L_attn_kernel_loopB:
  s_bitcmp1_b32 s27, s23
  s_cbranch_scc1 L_attn_kernel_baryB
L_attn_kernel_barbyB:
  v_exp_f32 v48, v48
  v_exp_f32 v49, v49
  v_exp_f32 v50, v50
  v_exp_f32 v51, v51
  v_exp_f32 v52, v52
  v_exp_f32 v53, v53
  v_exp_f32 v54, v54
  v_exp_f32 v55, v55
  s_setprio 1
  v_exp_f32 v56, v56
  v_exp_f32 v57, v57
  v_exp_f32 v58, v58
  v_exp_f32 v59, v59
  v_exp_f32 v60, v60
  v_exp_f32 v61, v61
  v_exp_f32 v62, v62
  v_exp_f32 v63, v63
  v_exp_f32 v64, v64
  v_exp_f32 v65, v65
  v_exp_f32 v66, v66
  v_exp_f32 v67, v67
  v_exp_f32 v68, v68
  v_exp_f32 v69, v69
  v_exp_f32 v70, v70
  v_exp_f32 v71, v71
  v_exp_f32 v72, v72
  v_exp_f32 v73, v73
  v_exp_f32 v74, v74
  v_exp_f32 v75, v75
  v_exp_f32 v76, v76
  v_exp_f32 v77, v77
  v_exp_f32 v78, v78
  v_exp_f32 v79, v79
L_attn_kernel_entryB:
  s_bitcmp1_b32 s26, s23
  s_cbranch_scc1 L_attn_kernel_barxB
L_attn_kernel_barbxB:
  s_waitcnt lgkmcnt(0)
  s_setprio 3
  v_mfma_f32_32x32x16_bf16 v[16:31], v[156:159], v[144:147], 0
  ds_read_b128 v[166:169], v1 offset:5120
  v_mfma_f32_32x32x16_bf16 v[32:47], v[160:163], v[144:147], 0
  ds_read_b128 v[170:173], v1 offset:6144
  v_smfmac_f32_32x32x32_bf16 v[96:111], v[192:195], v[48:55], v4
  ds_read_b64 v[174:175], v2 offset:5120
  v_mfma_f32_32x32x4_2b_bf16 v[16:47], v[164:165], v[152:153], v[16:47]
  v_smfmac_f32_32x32x32_bf16 v[96:111], v[196:199], v[56:63], v4
  v_smfmac_f32_32x32x32_bf16 v[96:111], v[200:203], v[64:71], v4
  v_smfmac_f32_32x32x32_bf16 v[96:111], v[204:207], v[72:79], v4
  s_setprio 0
  v_exp_f32 v16, v16
  v_exp_f32 v17, v17
  v_exp_f32 v18, v18
  v_exp_f32 v19, v19
  v_exp_f32 v20, v20
  v_exp_f32 v21, v21
  v_exp_f32 v22, v22
  v_exp_f32 v23, v23
  s_setprio 1
  v_exp_f32 v24, v24
  v_exp_f32 v25, v25
  v_exp_f32 v26, v26
  v_exp_f32 v27, v27
  v_exp_f32 v28, v28
  v_exp_f32 v29, v29
  v_exp_f32 v30, v30
  v_exp_f32 v31, v31
  v_exp_f32 v32, v32
  v_exp_f32 v33, v33
  v_exp_f32 v34, v34
  v_exp_f32 v35, v35
  v_exp_f32 v36, v36
  v_exp_f32 v37, v37
  v_exp_f32 v38, v38
  v_exp_f32 v39, v39
  v_exp_f32 v40, v40
  v_exp_f32 v41, v41
  v_exp_f32 v42, v42
  v_exp_f32 v43, v43
  v_exp_f32 v44, v44
  v_exp_f32 v45, v45
  v_exp_f32 v46, v46
  v_exp_f32 v47, v47
  s_setprio 3
  v_mfma_f32_32x32x16_bf16 v[48:63], v[156:159], v[148:151], 0
  v_mfma_f32_32x32x16_bf16 v[64:79], v[160:163], v[148:151], 0
  v_smfmac_f32_32x32x32_bf16 v[80:95], v[176:179], v[16:23], v4
  v_mfma_f32_32x32x4_2b_bf16 v[48:79], v[164:165], v[154:155], v[48:79]
  s_mov_b64 exec, s[30:31]
  ds_read_b128 v[192:195], v3 offset:5120
  ds_read_b128 v[196:199], v3 offset:5760
  ds_read_b128 v[200:203], v3 offset:6400
  ds_read_b128 v[204:207], v3 offset:7040
  s_mov_b64 exec, -1
  v_smfmac_f32_32x32x32_bf16 v[80:95], v[180:183], v[24:31], v4
  v_smfmac_f32_32x32x32_bf16 v[80:95], v[184:187], v[32:39], v4
  v_smfmac_f32_32x32x32_bf16 v[80:95], v[188:191], v[40:47], v4
  s_add_u32 s24, s24, 10240
  s_cmp_eq_u32 s24, 163840
  s_cselect_b32 s24, 0, s24
  v_add_u32 v1, s24, v0
  v_add_u32 v2, s24, v208
  v_add_u32 v3, s24, v209
  s_setprio 0
  v_exp_f32 v48, v48
  v_exp_f32 v49, v49
  v_exp_f32 v50, v50
  v_exp_f32 v51, v51
  v_exp_f32 v52, v52
  v_exp_f32 v53, v53
  v_exp_f32 v54, v54
  v_exp_f32 v55, v55
  s_setprio 1
  v_exp_f32 v56, v56
  v_exp_f32 v57, v57
  v_exp_f32 v58, v58
  v_exp_f32 v59, v59
  v_exp_f32 v60, v60
  v_exp_f32 v61, v61
  v_exp_f32 v62, v62
  v_exp_f32 v63, v63
  v_exp_f32 v64, v64
  v_exp_f32 v65, v65
  v_exp_f32 v66, v66
  v_exp_f32 v67, v67
  v_exp_f32 v68, v68
  v_exp_f32 v69, v69
  v_exp_f32 v70, v70
  v_exp_f32 v71, v71
  v_exp_f32 v72, v72
  v_exp_f32 v73, v73
  v_exp_f32 v74, v74
  v_exp_f32 v75, v75
  v_exp_f32 v76, v76
  v_exp_f32 v77, v77
  v_exp_f32 v78, v78
  v_exp_f32 v79, v79
  s_waitcnt lgkmcnt(0)
  s_setprio 3
  v_mfma_f32_32x32x16_bf16 v[16:31], v[166:169], v[144:147], 0
  ds_read_b128 v[156:159], v1 offset:0
  v_mfma_f32_32x32x16_bf16 v[32:47], v[170:173], v[144:147], 0
  ds_read_b128 v[160:163], v1 offset:1024
  v_smfmac_f32_32x32x32_bf16 v[96:111], v[176:179], v[48:55], v4
  ds_read_b64 v[164:165], v2 offset:0
  v_mfma_f32_32x32x4_2b_bf16 v[16:47], v[174:175], v[152:153], v[16:47]
  v_smfmac_f32_32x32x32_bf16 v[96:111], v[180:183], v[56:63], v4
  v_smfmac_f32_32x32x32_bf16 v[96:111], v[184:187], v[64:71], v4
  v_smfmac_f32_32x32x32_bf16 v[96:111], v[188:191], v[72:79], v4
  s_setprio 0
  v_exp_f32 v16, v16
  v_exp_f32 v17, v17
  v_exp_f32 v18, v18
  v_exp_f32 v19, v19
  v_exp_f32 v20, v20
  v_exp_f32 v21, v21
  v_exp_f32 v22, v22
  v_exp_f32 v23, v23
  s_setprio 1
  v_exp_f32 v24, v24
  v_exp_f32 v25, v25
  v_exp_f32 v26, v26
  v_exp_f32 v27, v27
  v_exp_f32 v28, v28
  v_exp_f32 v29, v29
  v_exp_f32 v30, v30
  v_exp_f32 v31, v31
  v_exp_f32 v32, v32
  v_exp_f32 v33, v33
  v_exp_f32 v34, v34
  v_exp_f32 v35, v35
  v_exp_f32 v36, v36
  v_exp_f32 v37, v37
  v_exp_f32 v38, v38
  v_exp_f32 v39, v39
  v_exp_f32 v40, v40
  v_exp_f32 v41, v41
  v_exp_f32 v42, v42
  v_exp_f32 v43, v43
  v_exp_f32 v44, v44
  v_exp_f32 v45, v45
  v_exp_f32 v46, v46
  v_exp_f32 v47, v47
  s_setprio 3
  v_mfma_f32_32x32x16_bf16 v[48:63], v[166:169], v[148:151], 0
  v_mfma_f32_32x32x16_bf16 v[64:79], v[170:173], v[148:151], 0
  v_smfmac_f32_32x32x32_bf16 v[80:95], v[192:195], v[16:23], v4
  v_mfma_f32_32x32x4_2b_bf16 v[48:79], v[174:175], v[154:155], v[48:79]
  s_mov_b64 exec, s[30:31]
  ds_read_b128 v[176:179], v3 offset:0
  ds_read_b128 v[180:183], v3 offset:640
  ds_read_b128 v[184:187], v3 offset:1280
  ds_read_b128 v[188:191], v3 offset:1920
  s_mov_b64 exec, -1
  v_smfmac_f32_32x32x32_bf16 v[80:95], v[196:199], v[24:31], v4
  v_smfmac_f32_32x32x32_bf16 v[80:95], v[200:203], v[32:39], v4
  s_add_u32 s23, s23, 1
  v_smfmac_f32_32x32x32_bf16 v[80:95], v[204:207], v[40:47], v4
  s_cmp_lt_u32 s23, 16
  s_setprio 0
  s_cbranch_scc1 L_attn_kernel_loopB
L_attn_kernel_tail:
  v_exp_f32 v48, v48
  v_exp_f32 v49, v49
  v_exp_f32 v50, v50
  v_exp_f32 v51, v51
  v_exp_f32 v52, v52
  v_exp_f32 v53, v53
  v_exp_f32 v54, v54
  v_exp_f32 v55, v55
  s_setprio 1
  v_exp_f32 v56, v56
  v_exp_f32 v57, v57
  v_exp_f32 v58, v58
  v_exp_f32 v59, v59
  v_exp_f32 v60, v60
  v_exp_f32 v61, v61
  v_exp_f32 v62, v62
  v_exp_f32 v63, v63
  v_exp_f32 v64, v64
  v_exp_f32 v65, v65
  v_exp_f32 v66, v66
  v_exp_f32 v67, v67
  v_exp_f32 v68, v68
  v_exp_f32 v69, v69
  v_exp_f32 v70, v70
  v_exp_f32 v71, v71
  v_exp_f32 v72, v72
  v_exp_f32 v73, v73
  v_exp_f32 v74, v74
  v_exp_f32 v75, v75
  v_exp_f32 v76, v76
  v_exp_f32 v77, v77
  v_exp_f32 v78, v78
  v_exp_f32 v79, v79
  s_setprio 0
  s_nop 0
  v_smfmac_f32_32x32x32_bf16 v[96:111], v[192:195], v[48:55], v4
  v_smfmac_f32_32x32x32_bf16 v[96:111], v[196:199], v[56:63], v4
  v_smfmac_f32_32x32x32_bf16 v[96:111], v[200:203], v[64:71], v4
  v_smfmac_f32_32x32x32_bf16 v[96:111], v[204:207], v[72:79], v4
  s_mov_b64 s[32:33], 0
  v_mov_b32 v7, v88
  v_mov_b32 v5, v88
  v_pk_mul_f32 v[16:17], v[80:81], 0
  v_pk_mul_f32 v[18:19], v[82:83], 0
  v_permlane32_swap_b32 v7, v5
  v_pk_fma_f32 v[16:17], v[84:85], 0, v[16:17]
  v_pk_fma_f32 v[18:19], v[86:87], 0, v[18:19]
  v_pk_fma_f32 v[16:17], v[88:89], 0, v[16:17]
  v_pk_fma_f32 v[18:19], v[90:91], 0, v[18:19]
  v_rcp_f32 v32, v5
  v_cmp_nle_f32 vcc, 0x2b800000, v5
  v_pk_add_f32 v[16:17], v[16:17], v[18:19]
  s_or_b64 s[32:33], s[32:33], vcc
  v_cmp_nge_f32 vcc, 0x5d800000, v5
  s_or_b64 s[32:33], s[32:33], vcc
  v_cmp_u_f32 vcc, v16, v17
  s_or_b64 s[32:33], s[32:33], vcc
  v_pk_mul_f32 v[80:81], v[80:81], v[32:33] op_sel_hi:[1,0]
  v_pk_mul_f32 v[82:83], v[82:83], v[32:33] op_sel_hi:[1,0]
  v_pk_mul_f32 v[84:85], v[84:85], v[32:33] op_sel_hi:[1,0]
  v_pk_mul_f32 v[86:87], v[86:87], v[32:33] op_sel_hi:[1,0]
  v_pk_mul_f32 v[88:89], v[88:89], v[32:33] op_sel_hi:[1,0]
  v_pk_mul_f32 v[90:91], v[90:91], v[32:33] op_sel_hi:[1,0]
  v_cvt_pk_bf16_f32 v20, v80, v81
  v_cvt_pk_bf16_f32 v21, v82, v83
  v_cvt_pk_bf16_f32 v22, v84, v85
  v_cvt_pk_bf16_f32 v23, v86, v87
  v_cvt_pk_bf16_f32 v24, v88, v89
  v_cvt_pk_bf16_f32 v25, v90, v91
  s_mov_b32 exec_hi, 0
  buffer_store_dwordx2 v[24:25], v223, s[16:19], 0 offen offset:1024 sc1
  s_mov_b64 exec, -1
  v_permlane32_swap_b32 v20, v22
  v_permlane32_swap_b32 v21, v23
  buffer_store_dwordx4 v[20:23], v222, s[12:15], 0 offen offset:0 sc1
  v_mov_b32 v7, v104
  v_mov_b32 v6, v104
  v_pk_mul_f32 v[16:17], v[96:97], 0
  v_pk_mul_f32 v[18:19], v[98:99], 0
  v_permlane32_swap_b32 v7, v6
  v_pk_fma_f32 v[16:17], v[100:101], 0, v[16:17]
  v_pk_fma_f32 v[18:19], v[102:103], 0, v[18:19]
  v_pk_fma_f32 v[16:17], v[104:105], 0, v[16:17]
  v_pk_fma_f32 v[18:19], v[106:107], 0, v[18:19]
  v_rcp_f32 v34, v6
  v_cmp_nle_f32 vcc, 0x2b800000, v6
  v_pk_add_f32 v[16:17], v[16:17], v[18:19]
  s_or_b64 s[32:33], s[32:33], vcc
  v_cmp_nge_f32 vcc, 0x5d800000, v6
  s_or_b64 s[32:33], s[32:33], vcc
  v_cmp_u_f32 vcc, v16, v17
  s_or_b64 s[32:33], s[32:33], vcc
  s_cmp_eq_u64 s[32:33], 0
  s_cbranch_scc1 L_attn_kernel_store
  s_cmp_eq_u32 s28, 0
  s_cbranch_scc1 L_attn_kernel_slow
L_attn_kernel_store:
  v_pk_mul_f32 v[96:97], v[96:97], v[34:35] op_sel_hi:[1,0]
  v_pk_mul_f32 v[98:99], v[98:99], v[34:35] op_sel_hi:[1,0]
  v_pk_mul_f32 v[100:101], v[100:101], v[34:35] op_sel_hi:[1,0]
  v_pk_mul_f32 v[102:103], v[102:103], v[34:35] op_sel_hi:[1,0]
  v_pk_mul_f32 v[104:105], v[104:105], v[34:35] op_sel_hi:[1,0]
  v_pk_mul_f32 v[106:107], v[106:107], v[34:35] op_sel_hi:[1,0]
  v_cvt_pk_bf16_f32 v26, v96, v97
  v_cvt_pk_bf16_f32 v27, v98, v99
  v_cvt_pk_bf16_f32 v28, v100, v101
  v_cvt_pk_bf16_f32 v29, v102, v103
  v_cvt_pk_bf16_f32 v30, v104, v105
  v_cvt_pk_bf16_f32 v31, v106, v107
  s_mov_b32 exec_hi, 0
  buffer_store_dwordx2 v[30:31], v223, s[16:19], 0 offen offset:2304 sc1
  s_mov_b64 exec, -1
  v_permlane32_swap_b32 v26, v28
  v_permlane32_swap_b32 v27, v29
  buffer_store_dwordx4 v[26:29], v222, s[12:15], 0 offen offset:1280 sc1
  s_endpgm
L_attn_kernel_baryA:
  s_cmp_lg_u32 s23, 1
  s_cbranch_scc1 L_attn_kernel_baryA_0
  s_waitcnt vmcnt(1)
  s_barrier
  s_branch L_attn_kernel_barbyA
L_attn_kernel_baryA_0:
  s_waitcnt vmcnt(0)
  s_barrier
  s_cmp_eq_u32 s80, 0
  s_cbranch_scc1 L_attn_kernel_nowosyA
  s_lshl_b32 s32, s68, 10
  s_add_u32 s32, s32, 10649600
  s_add_u32 s8, s20, s32
  s_addc_u32 s9, s21, 0
  s_and_b32 s9, s9, 0xffff
  s_mov_b32 s10, 1024
  s_mov_b32 s11, 0x20000
  v_lshl_or_b32 v212, v216, 16, v212
  v_lshl_or_b32 v213, v217, 16, v213
  v_lshl_or_b32 v214, v218, 16, v214
  v_lshl_or_b32 v215, v219, 16, v215
  buffer_store_dwordx4 v[212:215], v0, s[8:11], 0 offen sc1
L_attn_kernel_nowosyA:
  s_branch L_attn_kernel_barbyA
L_attn_kernel_barxA:
  s_cmp_lg_u32 s23, 1
  s_cbranch_scc1 L_attn_kernel_barxA_0
  s_waitcnt vmcnt(1)
  s_barrier
  s_branch L_attn_kernel_barbxA
L_attn_kernel_barxA_0:
  s_waitcnt vmcnt(0)
  s_barrier
  s_cmp_eq_u32 s80, 0
  s_cbranch_scc1 L_attn_kernel_nowosxA
  s_lshl_b32 s32, s68, 10
  s_add_u32 s32, s32, 10649600
  s_add_u32 s8, s20, s32
  s_addc_u32 s9, s21, 0
  s_and_b32 s9, s9, 0xffff
  s_mov_b32 s10, 1024
  s_mov_b32 s11, 0x20000
  v_lshl_or_b32 v212, v216, 16, v212
  v_lshl_or_b32 v213, v217, 16, v213
  v_lshl_or_b32 v214, v218, 16, v214
  v_lshl_or_b32 v215, v219, 16, v215
  buffer_store_dwordx4 v[212:215], v0, s[8:11], 0 offen sc1
L_attn_kernel_nowosxA:
  s_branch L_attn_kernel_barbxA
L_attn_kernel_baryB:
  s_cmp_lg_u32 s23, 1
  s_cbranch_scc1 L_attn_kernel_baryB_0
  s_waitcnt vmcnt(1)
  s_barrier
  s_branch L_attn_kernel_barbyB
L_attn_kernel_baryB_0:
  s_waitcnt vmcnt(0)
  s_barrier
  s_cmp_eq_u32 s80, 0
  s_cbranch_scc1 L_attn_kernel_nowosyB
  s_lshl_b32 s32, s68, 10
  s_add_u32 s32, s32, 10649600
  s_add_u32 s8, s20, s32
  s_addc_u32 s9, s21, 0
  s_and_b32 s9, s9, 0xffff
  s_mov_b32 s10, 1024
  s_mov_b32 s11, 0x20000
  v_lshl_or_b32 v212, v216, 16, v212
  v_lshl_or_b32 v213, v217, 16, v213
  v_lshl_or_b32 v214, v218, 16, v214
  v_lshl_or_b32 v215, v219, 16, v215
  buffer_store_dwordx4 v[212:215], v0, s[8:11], 0 offen sc1
L_attn_kernel_nowosyB:
  s_branch L_attn_kernel_barbyB
L_attn_kernel_barxB:
  s_cmp_lg_u32 s23, 1
  s_cbranch_scc1 L_attn_kernel_barxB_0
  s_waitcnt vmcnt(1)
  s_barrier
  s_branch L_attn_kernel_barbxB
L_attn_kernel_barxB_0:
  s_waitcnt vmcnt(0)
  s_barrier
  s_cmp_eq_u32 s80, 0
  s_cbranch_scc1 L_attn_kernel_nowosxB
  s_lshl_b32 s32, s68, 10
  s_add_u32 s32, s32, 10649600
  s_add_u32 s8, s20, s32
  s_addc_u32 s9, s21, 0
  s_and_b32 s9, s9, 0xffff
  s_mov_b32 s10, 1024
  s_mov_b32 s11, 0x20000
  v_lshl_or_b32 v212, v216, 16, v212
  v_lshl_or_b32 v213, v217, 16, v213
  v_lshl_or_b32 v214, v218, 16, v214
  v_lshl_or_b32 v215, v219, 16, v215
  buffer_store_dwordx4 v[212:215], v0, s[8:11], 0 offen sc1
L_attn_kernel_nowosxB:
  s_branch L_attn_kernel_barbxB
L_attn_kernel_slow:
  v_mov_b32 v12, 0xff800000
  v_mov_b32 v13, 0xff800000
  s_mov_b32 s24, 0
L_attn_kernel_mx:
  v_add_u32 v1, s24, v0
  v_add_u32 v2, s24, v208
  v_add_u32 v3, s24, v209
  ds_read_b128 v[156:159], v1 offset:0
  ds_read_b128 v[160:163], v1 offset:1024
  ds_read_b64 v[164:165], v2 offset:0
  s_waitcnt lgkmcnt(0)
  v_mfma_f32_32x32x16_bf16 v[16:31], v[156:159], v[144:147], 0
  v_mfma_f32_32x32x16_bf16 v[32:47], v[160:163], v[144:147], 0
  v_mfma_f32_32x32x16_bf16 v[48:63], v[156:159], v[148:151], 0
  v_mfma_f32_32x32x16_bf16 v[64:79], v[160:163], v[148:151], 0
  s_nop 15
  v_mfma_f32_32x32x4_2b_bf16 v[16:47], v[164:165], v[152:153], v[16:47]
  v_mfma_f32_32x32x4_2b_bf16 v[48:79], v[164:165], v[154:155], v[48:79]
  s_nop 15
  s_nop 7
  v_max3_f32 v12, v16, v17, v12
  v_max3_f32 v12, v18, v19, v12
  v_max3_f32 v12, v20, v21, v12
  v_max3_f32 v12, v22, v23, v12
  v_max3_f32 v12, v24, v25, v12
  v_max3_f32 v12, v26, v27, v12
  v_max3_f32 v12, v28, v29, v12
  v_max3_f32 v12, v30, v31, v12
  v_max3_f32 v12, v32, v33, v12
  v_max3_f32 v12, v34, v35, v12
  v_max3_f32 v12, v36, v37, v12
  v_max3_f32 v12, v38, v39, v12
  v_max3_f32 v12, v40, v41, v12
  v_max3_f32 v12, v42, v43, v12
  v_max3_f32 v12, v44, v45, v12
  v_max3_f32 v12, v46, v47, v12
  v_max3_f32 v13, v48, v49, v13
  v_max3_f32 v13, v50, v51, v13
  v_max3_f32 v13, v52, v53, v13
  v_max3_f32 v13, v54, v55, v13
  v_max3_f32 v13, v56, v57, v13
  v_max3_f32 v13, v58, v59, v13
  v_max3_f32 v13, v60, v61, v13
  v_max3_f32 v13, v62, v63, v13
  v_max3_f32 v13, v64, v65, v13
  v_max3_f32 v13, v66, v67, v13
  v_max3_f32 v13, v68, v69, v13
  v_max3_f32 v13, v70, v71, v13
  v_max3_f32 v13, v72, v73, v13
  v_max3_f32 v13, v74, v75, v13
  v_max3_f32 v13, v76, v77, v13
  v_max3_f32 v13, v78, v79, v13
  s_add_u32 s24, s24, 5120
  s_cmp_lt_u32 s24, 163840
  s_cbranch_scc1 L_attn_kernel_mx
  v_mov_b32 v7, v12
  s_nop 1
  v_permlane32_swap_b32 v7, v12
  s_nop 1
  v_max_f32 v7, v7, v12
  v_sub_f32 v112, 0, v7
  v_sub_f32 v113, 0, v7
  v_sub_f32 v114, 0, v7
  v_sub_f32 v115, 0, v7
  v_sub_f32 v116, 0, v7
  v_sub_f32 v117, 0, v7
  v_sub_f32 v118, 0, v7
  v_sub_f32 v119, 0, v7
  v_sub_f32 v120, 0, v7
  v_sub_f32 v121, 0, v7
  v_sub_f32 v122, 0, v7
  v_sub_f32 v123, 0, v7
  v_sub_f32 v124, 0, v7
  v_sub_f32 v125, 0, v7
  v_sub_f32 v126, 0, v7
  v_sub_f32 v127, 0, v7
  v_mov_b32 v7, v13
  s_nop 1
  v_permlane32_swap_b32 v7, v13
  s_nop 1
  v_max_f32 v7, v7, v13
  v_sub_f32 v128, 0, v7
  v_sub_f32 v129, 0, v7
  v_sub_f32 v130, 0, v7
  v_sub_f32 v131, 0, v7
  v_sub_f32 v132, 0, v7
  v_sub_f32 v133, 0, v7
  v_sub_f32 v134, 0, v7
  v_sub_f32 v135, 0, v7
  v_sub_f32 v136, 0, v7
  v_sub_f32 v137, 0, v7
  v_sub_f32 v138, 0, v7
  v_sub_f32 v139, 0, v7
  v_sub_f32 v140, 0, v7
  v_sub_f32 v141, 0, v7
  v_sub_f32 v142, 0, v7
  v_sub_f32 v143, 0, v7
  s_mov_b32 s26, 0
  s_mov_b32 s27, 0
  s_mov_b32 s28, 1
  s_branch L_attn_kernel_run
.p2align 6
L_attn_kernel_loopC:
  v_exp_f32 v48, v48
  v_exp_f32 v49, v49
  v_exp_f32 v50, v50
  v_exp_f32 v51, v51
  v_exp_f32 v52, v52
  v_exp_f32 v53, v53
  v_exp_f32 v54, v54
  v_exp_f32 v55, v55
  s_setprio 1
  v_exp_f32 v56, v56
  v_exp_f32 v57, v57
  v_exp_f32 v58, v58
  v_exp_f32 v59, v59
  v_exp_f32 v60, v60
  v_exp_f32 v61, v61
  v_exp_f32 v62, v62
  v_exp_f32 v63, v63
  v_exp_f32 v64, v64
  v_exp_f32 v65, v65
  v_exp_f32 v66, v66
  v_exp_f32 v67, v67
  v_exp_f32 v68, v68
  v_exp_f32 v69, v69
  v_exp_f32 v70, v70
  v_exp_f32 v71, v71
  v_exp_f32 v72, v72
  v_exp_f32 v73, v73
  v_exp_f32 v74, v74
  v_exp_f32 v75, v75
  v_exp_f32 v76, v76
  v_exp_f32 v77, v77
  v_exp_f32 v78, v78
  v_exp_f32 v79, v79
L_attn_kernel_entryC:
  s_waitcnt lgkmcnt(0)
  s_setprio 3
  v_mfma_f32_32x32x16_bf16 v[16:31], v[156:159], v[144:147], v[112:127]
  ds_read_b128 v[166:169], v1 offset:5120
  v_mfma_f32_32x32x16_bf16 v[32:47], v[160:163], v[144:147], v[112:127]
  ds_read_b128 v[170:173], v1 offset:6144
  v_smfmac_f32_32x32x32_bf16 v[96:111], v[192:195], v[48:55], v4
  ds_read_b64 v[174:175], v2 offset:5120
  v_mfma_f32_32x32x4_2b_bf16 v[16:47], v[164:165], v[152:153], v[16:47]
  v_smfmac_f32_32x32x32_bf16 v[96:111], v[196:199], v[56:63], v4
  v_smfmac_f32_32x32x32_bf16 v[96:111], v[200:203], v[64:71], v4
  v_smfmac_f32_32x32x32_bf16 v[96:111], v[204:207], v[72:79], v4
  s_setprio 0
  v_exp_f32 v16, v16
  v_exp_f32 v17, v17
  v_exp_f32 v18, v18
  v_exp_f32 v19, v19
  v_exp_f32 v20, v20
  v_exp_f32 v21, v21
  v_exp_f32 v22, v22
  v_exp_f32 v23, v23
  s_setprio 1
  v_exp_f32 v24, v24
  v_exp_f32 v25, v25
  v_exp_f32 v26, v26
  v_exp_f32 v27, v27
  v_exp_f32 v28, v28
  v_exp_f32 v29, v29
  v_exp_f32 v30, v30
  v_exp_f32 v31, v31
  v_exp_f32 v32, v32
  v_exp_f32 v33, v33
  v_exp_f32 v34, v34
  v_exp_f32 v35, v35
  v_exp_f32 v36, v36
  v_exp_f32 v37, v37
  v_exp_f32 v38, v38
  v_exp_f32 v39, v39
  v_exp_f32 v40, v40
  v_exp_f32 v41, v41
  v_exp_f32 v42, v42
  v_exp_f32 v43, v43
  v_exp_f32 v44, v44
  v_exp_f32 v45, v45
  v_exp_f32 v46, v46
  v_exp_f32 v47, v47
  s_setprio 3
  v_mfma_f32_32x32x16_bf16 v[48:63], v[156:159], v[148:151], v[128:143]
  v_mfma_f32_32x32x16_bf16 v[64:79], v[160:163], v[148:151], v[128:143]
  v_smfmac_f32_32x32x32_bf16 v[80:95], v[176:179], v[16:23], v4
  v_mfma_f32_32x32x4_2b_bf16 v[48:79], v[164:165], v[154:155], v[48:79]
  s_mov_b64 exec, s[30:31]
  ds_read_b128 v[192:195], v3 offset:5120
  ds_read_b128 v[196:199], v3 offset:5760
  ds_read_b128 v[200:203], v3 offset:6400
  ds_read_b128 v[204:207], v3 offset:7040
  s_mov_b64 exec, -1
  v_smfmac_f32_32x32x32_bf16 v[80:95], v[180:183], v[24:31], v4
  v_smfmac_f32_32x32x32_bf16 v[80:95], v[184:187], v[32:39], v4
  v_smfmac_f32_32x32x32_bf16 v[80:95], v[188:191], v[40:47], v4
  s_add_u32 s24, s24, 10240
  s_cmp_eq_u32 s24, 163840
  s_cselect_b32 s24, 0, s24
  v_add_u32 v1, s24, v0
  v_add_u32 v2, s24, v208
  v_add_u32 v3, s24, v209
  s_setprio 0
  v_exp_f32 v48, v48
  v_exp_f32 v49, v49
  v_exp_f32 v50, v50
  v_exp_f32 v51, v51
  v_exp_f32 v52, v52
  v_exp_f32 v53, v53
  v_exp_f32 v54, v54
  v_exp_f32 v55, v55
  s_setprio 1
  v_exp_f32 v56, v56
  v_exp_f32 v57, v57
  v_exp_f32 v58, v58
  v_exp_f32 v59, v59
  v_exp_f32 v60, v60
  v_exp_f32 v61, v61
  v_exp_f32 v62, v62
  v_exp_f32 v63, v63
  v_exp_f32 v64, v64
  v_exp_f32 v65, v65
  v_exp_f32 v66, v66
  v_exp_f32 v67, v67
  v_exp_f32 v68, v68
  v_exp_f32 v69, v69
  v_exp_f32 v70, v70
  v_exp_f32 v71, v71
  v_exp_f32 v72, v72
  v_exp_f32 v73, v73
  v_exp_f32 v74, v74
  v_exp_f32 v75, v75
  v_exp_f32 v76, v76
  v_exp_f32 v77, v77
  v_exp_f32 v78, v78
  v_exp_f32 v79, v79
  s_waitcnt lgkmcnt(0)
  s_setprio 3
  v_mfma_f32_32x32x16_bf16 v[16:31], v[166:169], v[144:147], v[112:127]
  ds_read_b128 v[156:159], v1 offset:0
  v_mfma_f32_32x32x16_bf16 v[32:47], v[170:173], v[144:147], v[112:127]
  ds_read_b128 v[160:163], v1 offset:1024
  v_smfmac_f32_32x32x32_bf16 v[96:111], v[176:179], v[48:55], v4
  ds_read_b64 v[164:165], v2 offset:0
  v_mfma_f32_32x32x4_2b_bf16 v[16:47], v[174:175], v[152:153], v[16:47]
  v_smfmac_f32_32x32x32_bf16 v[96:111], v[180:183], v[56:63], v4
  v_smfmac_f32_32x32x32_bf16 v[96:111], v[184:187], v[64:71], v4
  v_smfmac_f32_32x32x32_bf16 v[96:111], v[188:191], v[72:79], v4
  s_setprio 0
  v_exp_f32 v16, v16
  v_exp_f32 v17, v17
  v_exp_f32 v18, v18
  v_exp_f32 v19, v19
  v_exp_f32 v20, v20
  v_exp_f32 v21, v21
  v_exp_f32 v22, v22
  v_exp_f32 v23, v23
  s_setprio 1
  v_exp_f32 v24, v24
  v_exp_f32 v25, v25
  v_exp_f32 v26, v26
  v_exp_f32 v27, v27
  v_exp_f32 v28, v28
  v_exp_f32 v29, v29
  v_exp_f32 v30, v30
  v_exp_f32 v31, v31
  v_exp_f32 v32, v32
  v_exp_f32 v33, v33
  v_exp_f32 v34, v34
  v_exp_f32 v35, v35
  v_exp_f32 v36, v36
  v_exp_f32 v37, v37
  v_exp_f32 v38, v38
  v_exp_f32 v39, v39
  v_exp_f32 v40, v40
  v_exp_f32 v41, v41
  v_exp_f32 v42, v42
  v_exp_f32 v43, v43
  v_exp_f32 v44, v44
  v_exp_f32 v45, v45
  v_exp_f32 v46, v46
  v_exp_f32 v47, v47
  s_setprio 3
  v_mfma_f32_32x32x16_bf16 v[48:63], v[166:169], v[148:151], v[128:143]
  v_mfma_f32_32x32x16_bf16 v[64:79], v[170:173], v[148:151], v[128:143]
  v_smfmac_f32_32x32x32_bf16 v[80:95], v[192:195], v[16:23], v4
  v_mfma_f32_32x32x4_2b_bf16 v[48:79], v[174:175], v[154:155], v[48:79]
  s_mov_b64 exec, s[30:31]
  ds_read_b128 v[176:179], v3 offset:0
  ds_read_b128 v[180:183], v3 offset:640
  ds_read_b128 v[184:187], v3 offset:1280
  ds_read_b128 v[188:191], v3 offset:1920
  s_mov_b64 exec, -1
  v_smfmac_f32_32x32x32_bf16 v[80:95], v[196:199], v[24:31], v4
  v_smfmac_f32_32x32x32_bf16 v[80:95], v[200:203], v[32:39], v4
  s_add_u32 s23, s23, 1
  v_smfmac_f32_32x32x32_bf16 v[80:95], v[204:207], v[40:47], v4
  s_cmp_lt_u32 s23, 16
  s_setprio 0
  s_cbranch_scc1 L_attn_kernel_loopC
  s_branch L_attn_kernel_tail
L_attn_kernel_end:
  s_endpgm
.text
.globl outp_kernel
.p2align 8
.type outp_kernel,@function
outp_kernel:
  s_cmp_ge_u32 s2, 256
  s_cbranch_scc1 L_outp_kernel_end
  s_load_dwordx2 s[24:25], s[0:1], 80
  s_load_dwordx2 s[26:27], s[0:1], 64
  v_lshrrev_b32 v1, 6, v0
  v_and_b32 v0, 63, v0
  v_readfirstlane_b32 s20, v1
  s_and_b32 s32, s2, 7
  s_lshr_b32 s33, s2, 3
  s_lshr_b32 s21, s32, 2
  s_and_b32 s34, s32, 3
  s_lshl_b32 s34, s34, 2
  s_lshr_b32 s35, s33, 3
  s_add_u32 s22, s34, s35
  s_and_b32 s23, s33, 7
  v_lshlrev_b32 v1, 4, v0
  s_cmp_ge_u32 s20, 4
  s_cbranch_scc0 L_outp_kernel_cons
  s_setprio 3
  s_lshl_b32 s32, s21, 3
  s_add_u32 s32, s32, s23
  s_mul_i32 s32, s32, 102400
  s_add_u32 s32, s32, 10649600
  s_sub_u32 s30, s20, 4
  s_mul_i32 s30, s30, 5120
  s_waitcnt lgkmcnt(0)
  s_add_u32 s12, s24, s32
  s_addc_u32 s13, s25, 0
  s_and_b32 s13, s13, 0xffff
  s_mov_b32 s14, 102400
  s_mov_b32 s15, 0x20000
  s_add_u32 m0, s30, 0
  s_add_u32 s32, s30, 0
  buffer_load_dwordx4 v1, s[12:15], s32 offen lds
  s_add_u32 m0, s30, 1024
  s_add_u32 s32, s30, 1024
  buffer_load_dwordx4 v1, s[12:15], s32 offen lds
  s_add_u32 m0, s30, 2048
  s_add_u32 s32, s30, 2048
  buffer_load_dwordx4 v1, s[12:15], s32 offen lds
  s_add_u32 m0, s30, 3072
  s_add_u32 s32, s30, 3072
  buffer_load_dwordx4 v1, s[12:15], s32 offen lds
  s_add_u32 m0, s30, 4096
  s_add_u32 s32, s30, 4096
  buffer_load_dwordx4 v1, s[12:15], s32 offen lds
  s_add_u32 s30, s30, 20480
  s_waitcnt vmcnt(0)
  s_barrier
  s_add_u32 m0, s30, 0
  s_add_u32 s32, s30, 0
  buffer_load_dwordx4 v1, s[12:15], s32 offen lds
  s_add_u32 m0, s30, 1024
  s_add_u32 s32, s30, 1024
  buffer_load_dwordx4 v1, s[12:15], s32 offen lds
  s_add_u32 m0, s30, 2048
  s_add_u32 s32, s30, 2048
  buffer_load_dwordx4 v1, s[12:15], s32 offen lds
  s_add_u32 m0, s30, 3072
  s_add_u32 s32, s30, 3072
  buffer_load_dwordx4 v1, s[12:15], s32 offen lds
  s_add_u32 m0, s30, 4096
  s_add_u32 s32, s30, 4096
  buffer_load_dwordx4 v1, s[12:15], s32 offen lds
  s_add_u32 s30, s30, 20480
  s_add_u32 m0, s30, 0
  s_add_u32 s32, s30, 0
  buffer_load_dwordx4 v1, s[12:15], s32 offen lds
  s_add_u32 m0, s30, 1024
  s_add_u32 s32, s30, 1024
  buffer_load_dwordx4 v1, s[12:15], s32 offen lds
  s_add_u32 m0, s30, 2048
  s_add_u32 s32, s30, 2048
  buffer_load_dwordx4 v1, s[12:15], s32 offen lds
  s_add_u32 m0, s30, 3072
  s_add_u32 s32, s30, 3072
  buffer_load_dwordx4 v1, s[12:15], s32 offen lds
  s_add_u32 m0, s30, 4096
  s_add_u32 s32, s30, 4096
  buffer_load_dwordx4 v1, s[12:15], s32 offen lds
  s_add_u32 s30, s30, 20480
  s_waitcnt vmcnt(5)
  s_barrier
  s_add_u32 m0, s30, 0
  s_add_u32 s32, s30, 0
  buffer_load_dwordx4 v1, s[12:15], s32 offen lds
  s_add_u32 m0, s30, 1024
  s_add_u32 s32, s30, 1024
  buffer_load_dwordx4 v1, s[12:15], s32 offen lds
  s_add_u32 m0, s30, 2048
  s_add_u32 s32, s30, 2048
  buffer_load_dwordx4 v1, s[12:15], s32 offen lds
  s_add_u32 m0, s30, 3072
  s_add_u32 s32, s30, 3072
  buffer_load_dwordx4 v1, s[12:15], s32 offen lds
  s_add_u32 m0, s30, 4096
  s_add_u32 s32, s30, 4096
  buffer_load_dwordx4 v1, s[12:15], s32 offen lds
  s_add_u32 s30, s30, 20480
  s_waitcnt vmcnt(5)
  s_barrier
  s_add_u32 m0, s30, 0
  s_add_u32 s32, s30, 0
  buffer_load_dwordx4 v1, s[12:15], s32 offen lds
  s_add_u32 m0, s30, 1024
  s_add_u32 s32, s30, 1024
  buffer_load_dwordx4 v1, s[12:15], s32 offen lds
  s_add_u32 m0, s30, 2048
  s_add_u32 s32, s30, 2048
  buffer_load_dwordx4 v1, s[12:15], s32 offen lds
  s_add_u32 m0, s30, 3072
  s_add_u32 s32, s30, 3072
  buffer_load_dwordx4 v1, s[12:15], s32 offen lds
  s_add_u32 m0, s30, 4096
  s_add_u32 s32, s30, 4096
  buffer_load_dwordx4 v1, s[12:15], s32 offen lds
  s_add_u32 s30, s30, 20480
  s_waitcnt vmcnt(5)
  s_barrier
  s_waitcnt vmcnt(0)
  s_barrier
  s_endpgm
L_outp_kernel_cons:
  v_and_b32 v5, 15, v0
  v_lshrrev_b32 v6, 4, v0
  v_lshrrev_b32 v7, 1, v6
  v_and_b32 v6, 1, v6
  v_mul_u32_u24 v7, 81920, v7
  v_lshl_add_u32 v7, v5, 5, v7
  v_lshl_add_u32 v2, v6, 4, v7
  v_mov_b32 v3, v1
  s_lshl_b32 s32, s22, 7
  s_lshl_b32 s33, s20, 5
  s_add_u32 s32, s32, s33
  s_lshr_b32 s33, s32, 5
  s_mul_i32 s33, s33, 1280
  s_mul_i32 s34, s21, 2621440
  s_add_u32 s34, s34, s33
  s_add_u32 s34, s34, 5406720
  s_add_u32 s35, s34, 1024
  v_lshrrev_b32 v6, 4, v0
  v_mul_u32_u24 v6, 163840, v6
  v_lshl_add_u32 v12, v5, 3, v6
  s_mul_i32 s36, s32, 2560
  s_mul_i32 s37, s21, 1280
  s_add_u32 s36, s36, s37
  s_mul_i32 s37, s23, 160
  s_add_u32 s36, s36, s37
  v_lshrrev_b32 v6, 4, v0
  v_and_b32 v7, 1, v6
  v_lshl_add_u32 v7, v7, 4, v5
  v_mul_u32_u24 v7, 2560, v7
  v_lshrrev_b32 v6, 1, v6
  v_lshl_add_u32 v4, v6, 4, v7
  v_mul_u32_u24 v7, 2560, v5
  v_lshl_add_u32 v7, v6, 4, v7
  v_bfe_u32 v6, v0, 4, 1
  v_lshl_add_u32 v11, v6, 5, v7
  s_waitcnt lgkmcnt(0)
  s_add_u32 s4, s24, s34
  s_addc_u32 s5, s25, 0
  s_and_b32 s5, s5, 0xffff
  s_mov_b32 s6, 2621440
  s_mov_b32 s7, 0x20000
  s_add_u32 s8, s24, s35
  s_addc_u32 s9, s25, 0
  s_and_b32 s9, s9, 0xffff
  s_mov_b32 s10, 2621440
  s_mov_b32 s11, 0x20000
  s_add_u32 s16, s26, s36
  s_addc_u32 s17, s27, 0
  s_and_b32 s17, s17, 0xffff
  s_mov_b32 s18, 81920
  s_mov_b32 s19, 0x20000
  s_mov_b32 s38, 0
  buffer_load_dwordx4 v[96:99], v2, s[4:7], s38 offen offset:0
  s_mov_b32 s38, 0
  buffer_load_dwordx4 v[100:103], v2, s[4:7], s38 offen offset:512
  s_mov_b32 s38, 163840
  buffer_load_dwordx4 v[104:107], v2, s[4:7], s38 offen offset:0
  s_mov_b32 s38, 163840
  buffer_load_dwordx4 v[108:111], v2, s[4:7], s38 offen offset:512
  s_mov_b32 s38, 327680
  buffer_load_dwordx4 v[112:115], v2, s[4:7], s38 offen offset:0
  s_mov_b32 s38, 327680
  buffer_load_dwordx4 v[116:119], v2, s[4:7], s38 offen offset:512
  s_mov_b32 s38, 491520
  buffer_load_dwordx4 v[120:123], v2, s[4:7], s38 offen offset:0
  s_mov_b32 s38, 491520
  buffer_load_dwordx4 v[124:127], v2, s[4:7], s38 offen offset:512
  v_add_u32 v5, 61440, v3
  s_barrier
  ds_read_b128 v[56:59], v3 offset:0
  ds_read_b128 v[60:63], v3 offset:1024
  ds_read_b128 v[64:67], v3 offset:2048
  ds_read_b128 v[68:71], v3 offset:3072
  ds_read_b128 v[72:75], v3 offset:4096
  s_mov_b32 s38, 655360
  buffer_load_dwordx4 v[128:131], v2, s[4:7], s38 offen offset:0
  s_mov_b32 s38, 655360
  buffer_load_dwordx4 v[132:135], v2, s[4:7], s38 offen offset:512
  s_mov_b32 s38, 819200
  buffer_load_dwordx4 v[136:139], v2, s[4:7], s38 offen offset:0
  s_mov_b32 s38, 819200
  buffer_load_dwordx4 v[140:143], v2, s[4:7], s38 offen offset:512
  s_mov_b32 s38, 983040
  buffer_load_dwordx4 v[144:147], v2, s[4:7], s38 offen offset:0
  s_mov_b32 s38, 983040
  buffer_load_dwordx4 v[148:151], v2, s[4:7], s38 offen offset:512
  s_mov_b32 s38, 1146880
  buffer_load_dwordx4 v[152:155], v2, s[4:7], s38 offen offset:0
  s_mov_b32 s38, 1146880
  buffer_load_dwordx4 v[156:159], v2, s[4:7], s38 offen offset:512
  s_waitcnt vmcnt(14) lgkmcnt(0)
  v_mfma_f32_16x16x32_bf16 v[16:19], v[56:59], v[96:99], 0
  ds_read_b128 v[76:79], v3 offset:5120
  v_mfma_f32_16x16x32_bf16 v[36:39], v[56:59], v[100:103], 0
  ds_read_b128 v[80:83], v3 offset:6144
  v_mfma_f32_16x16x32_bf16 v[20:23], v[60:63], v[96:99], 0
  ds_read_b128 v[84:87], v3 offset:7168
  v_mfma_f32_16x16x32_bf16 v[40:43], v[60:63], v[100:103], 0
  ds_read_b128 v[88:91], v3 offset:8192
  v_mfma_f32_16x16x32_bf16 v[24:27], v[64:67], v[96:99], 0
  ds_read_b128 v[92:95], v3 offset:9216
  v_mfma_f32_16x16x32_bf16 v[44:47], v[64:67], v[100:103], 0
  s_mov_b32 s38, 1310720
  buffer_load_dwordx4 v[160:163], v2, s[4:7], s38 offen offset:0
  v_mfma_f32_16x16x32_bf16 v[28:31], v[68:71], v[96:99], 0
  s_mov_b32 s38, 1310720
  buffer_load_dwordx4 v[164:167], v2, s[4:7], s38 offen offset:512
  v_mfma_f32_16x16x32_bf16 v[48:51], v[68:71], v[100:103], 0
  v_mfma_f32_16x16x32_bf16 v[32:35], v[72:75], v[96:99], 0
  v_mfma_f32_16x16x32_bf16 v[52:55], v[72:75], v[100:103], 0
  s_waitcnt vmcnt(14) lgkmcnt(0)
  v_mfma_f32_16x16x32_bf16 v[16:19], v[76:79], v[104:107], v[16:19]
  ds_read_b128 v[56:59], v3 offset:10240
  v_mfma_f32_16x16x32_bf16 v[36:39], v[76:79], v[108:111], v[36:39]
  ds_read_b128 v[60:63], v3 offset:11264
  v_mfma_f32_16x16x32_bf16 v[20:23], v[80:83], v[104:107], v[20:23]
  ds_read_b128 v[64:67], v3 offset:12288
  v_mfma_f32_16x16x32_bf16 v[40:43], v[80:83], v[108:111], v[40:43]
  ds_read_b128 v[68:71], v3 offset:13312
  v_mfma_f32_16x16x32_bf16 v[24:27], v[84:87], v[104:107], v[24:27]
  ds_read_b128 v[72:75], v3 offset:14336
  v_mfma_f32_16x16x32_bf16 v[44:47], v[84:87], v[108:111], v[44:47]
  s_mov_b32 s38, 1474560
  buffer_load_dwordx4 v[168:171], v2, s[4:7], s38 offen offset:0
  v_mfma_f32_16x16x32_bf16 v[28:31], v[88:91], v[104:107], v[28:31]
  s_mov_b32 s38, 1474560
  buffer_load_dwordx4 v[172:175], v2, s[4:7], s38 offen offset:512
  v_mfma_f32_16x16x32_bf16 v[48:51], v[88:91], v[108:111], v[48:51]
  v_mfma_f32_16x16x32_bf16 v[32:35], v[92:95], v[104:107], v[32:35]
  v_mfma_f32_16x16x32_bf16 v[52:55], v[92:95], v[108:111], v[52:55]
  s_waitcnt vmcnt(14) lgkmcnt(0)
  v_mfma_f32_16x16x32_bf16 v[16:19], v[56:59], v[112:115], v[16:19]
  ds_read_b128 v[76:79], v3 offset:15360
  v_mfma_f32_16x16x32_bf16 v[36:39], v[56:59], v[116:119], v[36:39]
  ds_read_b128 v[80:83], v3 offset:16384
  v_mfma_f32_16x16x32_bf16 v[20:23], v[60:63], v[112:115], v[20:23]
  ds_read_b128 v[84:87], v3 offset:17408
  v_mfma_f32_16x16x32_bf16 v[40:43], v[60:63], v[116:119], v[40:43]
  ds_read_b128 v[88:91], v3 offset:18432
  v_mfma_f32_16x16x32_bf16 v[24:27], v[64:67], v[112:115], v[24:27]
  ds_read_b128 v[92:95], v3 offset:19456
  v_mfma_f32_16x16x32_bf16 v[44:47], v[64:67], v[116:119], v[44:47]
  s_mov_b32 s38, 1638400
  buffer_load_dwordx4 v[176:179], v2, s[4:7], s38 offen offset:0
  v_mfma_f32_16x16x32_bf16 v[28:31], v[68:71], v[112:115], v[28:31]
  s_mov_b32 s38, 1638400
  buffer_load_dwordx4 v[180:183], v2, s[4:7], s38 offen offset:512
  v_mfma_f32_16x16x32_bf16 v[48:51], v[68:71], v[116:119], v[48:51]
  v_mfma_f32_16x16x32_bf16 v[32:35], v[72:75], v[112:115], v[32:35]
  v_mfma_f32_16x16x32_bf16 v[52:55], v[72:75], v[116:119], v[52:55]
  s_waitcnt vmcnt(14) lgkmcnt(0)
  s_barrier
  v_mfma_f32_16x16x32_bf16 v[16:19], v[76:79], v[120:123], v[16:19]
  ds_read_b128 v[56:59], v3 offset:20480
  v_mfma_f32_16x16x32_bf16 v[36:39], v[76:79], v[124:127], v[36:39]
  ds_read_b128 v[60:63], v3 offset:21504
  v_mfma_f32_16x16x32_bf16 v[20:23], v[80:83], v[120:123], v[20:23]
  ds_read_b128 v[64:67], v3 offset:22528
  v_mfma_f32_16x16x32_bf16 v[40:43], v[80:83], v[124:127], v[40:43]
  ds_read_b128 v[68:71], v3 offset:23552
  v_mfma_f32_16x16x32_bf16 v[24:27], v[84:87], v[120:123], v[24:27]
  ds_read_b128 v[72:75], v3 offset:24576
  v_mfma_f32_16x16x32_bf16 v[44:47], v[84:87], v[124:127], v[44:47]
  s_mov_b32 s38, 1802240
  buffer_load_dwordx4 v[184:187], v2, s[4:7], s38 offen offset:0
  v_mfma_f32_16x16x32_bf16 v[28:31], v[88:91], v[120:123], v[28:31]
  s_mov_b32 s38, 1802240
  buffer_load_dwordx4 v[188:191], v2, s[4:7], s38 offen offset:512
  v_mfma_f32_16x16x32_bf16 v[48:51], v[88:91], v[124:127], v[48:51]
  v_mfma_f32_16x16x32_bf16 v[32:35], v[92:95], v[120:123], v[32:35]
  v_mfma_f32_16x16x32_bf16 v[52:55], v[92:95], v[124:127], v[52:55]
  s_waitcnt vmcnt(14) lgkmcnt(0)
  v_mfma_f32_16x16x32_bf16 v[16:19], v[56:59], v[128:131], v[16:19]
  ds_read_b128 v[76:79], v3 offset:25600
  v_mfma_f32_16x16x32_bf16 v[36:39], v[56:59], v[132:135], v[36:39]
  ds_read_b128 v[80:83], v3 offset:26624
  v_mfma_f32_16x16x32_bf16 v[20:23], v[60:63], v[128:131], v[20:23]
  ds_read_b128 v[84:87], v3 offset:27648
  v_mfma_f32_16x16x32_bf16 v[40:43], v[60:63], v[132:135], v[40:43]
  ds_read_b128 v[88:91], v3 offset:28672
  v_mfma_f32_16x16x32_bf16 v[24:27], v[64:67], v[128:131], v[24:27]
  ds_read_b128 v[92:95], v3 offset:29696
  v_mfma_f32_16x16x32_bf16 v[44:47], v[64:67], v[132:135], v[44:47]
  s_mov_b32 s38, 1966080
  buffer_load_dwordx4 v[96:99], v2, s[4:7], s38 offen offset:0
  v_mfma_f32_16x16x32_bf16 v[28:31], v[68:71], v[128:131], v[28:31]
  s_mov_b32 s38, 1966080
  buffer_load_dwordx4 v[100:103], v2, s[4:7], s38 offen offset:512
  v_mfma_f32_16x16x32_bf16 v[48:51], v[68:71], v[132:135], v[48:51]
  v_mfma_f32_16x16x32_bf16 v[32:35], v[72:75], v[128:131], v[32:35]
  v_mfma_f32_16x16x32_bf16 v[52:55], v[72:75], v[132:135], v[52:55]
  s_waitcnt vmcnt(14) lgkmcnt(0)
  v_mfma_f32_16x16x32_bf16 v[16:19], v[76:79], v[136:139], v[16:19]
  ds_read_b128 v[56:59], v3 offset:30720
  v_mfma_f32_16x16x32_bf16 v[36:39], v[76:79], v[140:143], v[36:39]
  ds_read_b128 v[60:63], v3 offset:31744
  v_mfma_f32_16x16x32_bf16 v[20:23], v[80:83], v[136:139], v[20:23]
  ds_read_b128 v[64:67], v3 offset:32768
  v_mfma_f32_16x16x32_bf16 v[40:43], v[80:83], v[140:143], v[40:43]
  ds_read_b128 v[68:71], v3 offset:33792
  v_mfma_f32_16x16x32_bf16 v[24:27], v[84:87], v[136:139], v[24:27]
  ds_read_b128 v[72:75], v3 offset:34816
  v_mfma_f32_16x16x32_bf16 v[44:47], v[84:87], v[140:143], v[44:47]
  s_mov_b32 s38, 2129920
  buffer_load_dwordx4 v[104:107], v2, s[4:7], s38 offen offset:0
  v_mfma_f32_16x16x32_bf16 v[28:31], v[88:91], v[136:139], v[28:31]
  s_mov_b32 s38, 2129920
  buffer_load_dwordx4 v[108:111], v2, s[4:7], s38 offen offset:512
  v_mfma_f32_16x16x32_bf16 v[48:51], v[88:91], v[140:143], v[48:51]
  v_mfma_f32_16x16x32_bf16 v[32:35], v[92:95], v[136:139], v[32:35]
  v_mfma_f32_16x16x32_bf16 v[52:55], v[92:95], v[140:143], v[52:55]
  s_waitcnt vmcnt(14) lgkmcnt(0)
  v_mfma_f32_16x16x32_bf16 v[16:19], v[56:59], v[144:147], v[16:19]
  ds_read_b128 v[76:79], v3 offset:35840
  v_mfma_f32_16x16x32_bf16 v[36:39], v[56:59], v[148:151], v[36:39]
  ds_read_b128 v[80:83], v3 offset:36864
  v_mfma_f32_16x16x32_bf16 v[20:23], v[60:63], v[144:147], v[20:23]
  ds_read_b128 v[84:87], v3 offset:37888
  v_mfma_f32_16x16x32_bf16 v[40:43], v[60:63], v[148:151], v[40:43]
  ds_read_b128 v[88:91], v3 offset:38912
  v_mfma_f32_16x16x32_bf16 v[24:27], v[64:67], v[144:147], v[24:27]
  ds_read_b128 v[92:95], v3 offset:39936
  v_mfma_f32_16x16x32_bf16 v[44:47], v[64:67], v[148:151], v[44:47]
  s_mov_b32 s38, 2293760
  buffer_load_dwordx4 v[112:115], v2, s[4:7], s38 offen offset:0
  v_mfma_f32_16x16x32_bf16 v[28:31], v[68:71], v[144:147], v[28:31]
  s_mov_b32 s38, 2293760
  buffer_load_dwordx4 v[116:119], v2, s[4:7], s38 offen offset:512
  v_mfma_f32_16x16x32_bf16 v[48:51], v[68:71], v[148:151], v[48:51]
  v_mfma_f32_16x16x32_bf16 v[32:35], v[72:75], v[144:147], v[32:35]
  v_mfma_f32_16x16x32_bf16 v[52:55], v[72:75], v[148:151], v[52:55]
  s_waitcnt vmcnt(14) lgkmcnt(0)
  s_barrier
  v_mfma_f32_16x16x32_bf16 v[16:19], v[76:79], v[152:155], v[16:19]
  ds_read_b128 v[56:59], v3 offset:40960
  v_mfma_f32_16x16x32_bf16 v[36:39], v[76:79], v[156:159], v[36:39]
  ds_read_b128 v[60:63], v3 offset:41984
  v_mfma_f32_16x16x32_bf16 v[20:23], v[80:83], v[152:155], v[20:23]
  ds_read_b128 v[64:67], v3 offset:43008
  v_mfma_f32_16x16x32_bf16 v[40:43], v[80:83], v[156:159], v[40:43]
  ds_read_b128 v[68:71], v3 offset:44032
  v_mfma_f32_16x16x32_bf16 v[24:27], v[84:87], v[152:155], v[24:27]
  ds_read_b128 v[72:75], v3 offset:45056
  v_mfma_f32_16x16x32_bf16 v[44:47], v[84:87], v[156:159], v[44:47]
  s_mov_b32 s38, 2457600
  buffer_load_dwordx4 v[120:123], v2, s[4:7], s38 offen offset:0
  v_mfma_f32_16x16x32_bf16 v[28:31], v[88:91], v[152:155], v[28:31]
  s_mov_b32 s38, 2457600
  buffer_load_dwordx4 v[124:127], v2, s[4:7], s38 offen offset:512
  v_mfma_f32_16x16x32_bf16 v[48:51], v[88:91], v[156:159], v[48:51]
  v_mfma_f32_16x16x32_bf16 v[32:35], v[92:95], v[152:155], v[32:35]
  v_mfma_f32_16x16x32_bf16 v[52:55], v[92:95], v[156:159], v[52:55]
  s_waitcnt vmcnt(14) lgkmcnt(0)
  v_mfma_f32_16x16x32_bf16 v[16:19], v[56:59], v[160:163], v[16:19]
  ds_read_b128 v[76:79], v3 offset:46080
  v_mfma_f32_16x16x32_bf16 v[36:39], v[56:59], v[164:167], v[36:39]
  ds_read_b128 v[80:83], v3 offset:47104
  v_mfma_f32_16x16x32_bf16 v[20:23], v[60:63], v[160:163], v[20:23]
  ds_read_b128 v[84:87], v3 offset:48128
  v_mfma_f32_16x16x32_bf16 v[40:43], v[60:63], v[164:167], v[40:43]
  ds_read_b128 v[88:91], v3 offset:49152
  v_mfma_f32_16x16x32_bf16 v[24:27], v[64:67], v[160:163], v[24:27]
  ds_read_b128 v[92:95], v3 offset:50176
  v_mfma_f32_16x16x32_bf16 v[44:47], v[64:67], v[164:167], v[44:47]
  s_mov_b32 s38, 0
  buffer_load_dwordx2 v[128:129], v12, s[8:11], s38 offen offset:0
  s_mov_b32 s38, 81920
  buffer_load_dwordx2 v[130:131], v12, s[8:11], s38 offen offset:0
  v_mfma_f32_16x16x32_bf16 v[28:31], v[68:71], v[160:163], v[28:31]
  s_mov_b32 s38, 0
  buffer_load_dwordx2 v[132:133], v12, s[8:11], s38 offen offset:128
  s_mov_b32 s38, 81920
  buffer_load_dwordx2 v[134:135], v12, s[8:11], s38 offen offset:128
  v_mfma_f32_16x16x32_bf16 v[48:51], v[68:71], v[164:167], v[48:51]
  v_mfma_f32_16x16x32_bf16 v[32:35], v[72:75], v[160:163], v[32:35]
  v_mfma_f32_16x16x32_bf16 v[52:55], v[72:75], v[164:167], v[52:55]
  s_waitcnt vmcnt(16) lgkmcnt(0)
  v_mfma_f32_16x16x32_bf16 v[16:19], v[76:79], v[168:171], v[16:19]
  ds_read_b128 v[56:59], v3 offset:51200
  v_mfma_f32_16x16x32_bf16 v[36:39], v[76:79], v[172:175], v[36:39]
  ds_read_b128 v[60:63], v3 offset:52224
  v_mfma_f32_16x16x32_bf16 v[20:23], v[80:83], v[168:171], v[20:23]
  ds_read_b128 v[64:67], v3 offset:53248
  v_mfma_f32_16x16x32_bf16 v[40:43], v[80:83], v[172:175], v[40:43]
  ds_read_b128 v[68:71], v3 offset:54272
  v_mfma_f32_16x16x32_bf16 v[24:27], v[84:87], v[168:171], v[24:27]
  ds_read_b128 v[72:75], v3 offset:55296
  v_mfma_f32_16x16x32_bf16 v[44:47], v[84:87], v[172:175], v[44:47]
  s_mov_b32 s38, 655360
  buffer_load_dwordx2 v[136:137], v12, s[8:11], s38 offen offset:0
  s_mov_b32 s38, 737280
  buffer_load_dwordx2 v[138:139], v12, s[8:11], s38 offen offset:0
  v_mfma_f32_16x16x32_bf16 v[28:31], v[88:91], v[168:171], v[28:31]
  s_mov_b32 s38, 655360
  buffer_load_dwordx2 v[140:141], v12, s[8:11], s38 offen offset:128
  s_mov_b32 s38, 737280
  buffer_load_dwordx2 v[142:143], v12, s[8:11], s38 offen offset:128
  v_mfma_f32_16x16x32_bf16 v[48:51], v[88:91], v[172:175], v[48:51]
  v_mfma_f32_16x16x32_bf16 v[32:35], v[92:95], v[168:171], v[32:35]
  v_mfma_f32_16x16x32_bf16 v[52:55], v[92:95], v[172:175], v[52:55]
  s_waitcnt vmcnt(18) lgkmcnt(0)
  v_mfma_f32_16x16x32_bf16 v[16:19], v[56:59], v[176:179], v[16:19]
  ds_read_b128 v[76:79], v3 offset:56320
  v_mfma_f32_16x16x32_bf16 v[36:39], v[56:59], v[180:183], v[36:39]
  ds_read_b128 v[80:83], v3 offset:57344
  v_mfma_f32_16x16x32_bf16 v[20:23], v[60:63], v[176:179], v[20:23]
  ds_read_b128 v[84:87], v3 offset:58368
  v_mfma_f32_16x16x32_bf16 v[40:43], v[60:63], v[180:183], v[40:43]
  ds_read_b128 v[88:91], v3 offset:59392
  v_mfma_f32_16x16x32_bf16 v[24:27], v[64:67], v[176:179], v[24:27]
  ds_read_b128 v[92:95], v3 offset:60416
  v_mfma_f32_16x16x32_bf16 v[44:47], v[64:67], v[180:183], v[44:47]
  s_mov_b32 s38, 1310720
  buffer_load_dwordx2 v[144:145], v12, s[8:11], s38 offen offset:0
  s_mov_b32 s38, 1392640
  buffer_load_dwordx2 v[146:147], v12, s[8:11], s38 offen offset:0
  v_mfma_f32_16x16x32_bf16 v[28:31], v[68:71], v[176:179], v[28:31]
  s_mov_b32 s38, 1310720
  buffer_load_dwordx2 v[148:149], v12, s[8:11], s38 offen offset:128
  s_mov_b32 s38, 1392640
  buffer_load_dwordx2 v[150:151], v12, s[8:11], s38 offen offset:128
  v_mfma_f32_16x16x32_bf16 v[48:51], v[68:71], v[180:183], v[48:51]
  v_mfma_f32_16x16x32_bf16 v[32:35], v[72:75], v[176:179], v[32:35]
  v_mfma_f32_16x16x32_bf16 v[52:55], v[72:75], v[180:183], v[52:55]
  s_waitcnt vmcnt(20) lgkmcnt(0)
  s_barrier
  v_mfma_f32_16x16x32_bf16 v[16:19], v[76:79], v[184:187], v[16:19]
  ds_read_b128 v[56:59], v5 offset:0
  v_mfma_f32_16x16x32_bf16 v[36:39], v[76:79], v[188:191], v[36:39]
  ds_read_b128 v[60:63], v5 offset:1024
  v_mfma_f32_16x16x32_bf16 v[20:23], v[80:83], v[184:187], v[20:23]
  ds_read_b128 v[64:67], v5 offset:2048
  v_mfma_f32_16x16x32_bf16 v[40:43], v[80:83], v[188:191], v[40:43]
  ds_read_b128 v[68:71], v5 offset:3072
  v_mfma_f32_16x16x32_bf16 v[24:27], v[84:87], v[184:187], v[24:27]
  ds_read_b128 v[72:75], v5 offset:4096
  v_mfma_f32_16x16x32_bf16 v[44:47], v[84:87], v[188:191], v[44:47]
  s_mov_b32 s38, 1966080
  buffer_load_dwordx2 v[152:153], v12, s[8:11], s38 offen offset:0
  s_mov_b32 s38, 2048000
  buffer_load_dwordx2 v[154:155], v12, s[8:11], s38 offen offset:0
  v_mfma_f32_16x16x32_bf16 v[28:31], v[88:91], v[184:187], v[28:31]
  s_mov_b32 s38, 1966080
  buffer_load_dwordx2 v[156:157], v12, s[8:11], s38 offen offset:128
  s_mov_b32 s38, 2048000
  buffer_load_dwordx2 v[158:159], v12, s[8:11], s38 offen offset:128
  v_mfma_f32_16x16x32_bf16 v[48:51], v[88:91], v[188:191], v[48:51]
  v_mfma_f32_16x16x32_bf16 v[32:35], v[92:95], v[184:187], v[32:35]
  v_mfma_f32_16x16x32_bf16 v[52:55], v[92:95], v[188:191], v[52:55]
  s_waitcnt vmcnt(22) lgkmcnt(0)
  v_mfma_f32_16x16x32_bf16 v[16:19], v[56:59], v[96:99], v[16:19]
  ds_read_b128 v[76:79], v5 offset:5120
  v_mfma_f32_16x16x32_bf16 v[36:39], v[56:59], v[100:103], v[36:39]
  ds_read_b128 v[80:83], v5 offset:6144
  v_mfma_f32_16x16x32_bf16 v[20:23], v[60:63], v[96:99], v[20:23]
  ds_read_b128 v[84:87], v5 offset:7168
  v_mfma_f32_16x16x32_bf16 v[40:43], v[60:63], v[100:103], v[40:43]
  ds_read_b128 v[88:91], v5 offset:8192
  v_mfma_f32_16x16x32_bf16 v[24:27], v[64:67], v[96:99], v[24:27]
  ds_read_b128 v[92:95], v5 offset:9216
  v_mfma_f32_16x16x32_bf16 v[44:47], v[64:67], v[100:103], v[44:47]
  v_mfma_f32_16x16x32_bf16 v[28:31], v[68:71], v[96:99], v[28:31]
  v_mfma_f32_16x16x32_bf16 v[48:51], v[68:71], v[100:103], v[48:51]
  v_mfma_f32_16x16x32_bf16 v[32:35], v[72:75], v[96:99], v[32:35]
  v_mfma_f32_16x16x32_bf16 v[52:55], v[72:75], v[100:103], v[52:55]
  s_waitcnt vmcnt(20) lgkmcnt(0)
  v_mfma_f32_16x16x32_bf16 v[16:19], v[76:79], v[104:107], v[16:19]
  ds_read_b128 v[56:59], v5 offset:10240
  v_mfma_f32_16x16x32_bf16 v[36:39], v[76:79], v[108:111], v[36:39]
  ds_read_b128 v[60:63], v5 offset:11264
  v_mfma_f32_16x16x32_bf16 v[20:23], v[80:83], v[104:107], v[20:23]
  ds_read_b128 v[64:67], v5 offset:12288
  v_mfma_f32_16x16x32_bf16 v[40:43], v[80:83], v[108:111], v[40:43]
  ds_read_b128 v[68:71], v5 offset:13312
  v_mfma_f32_16x16x32_bf16 v[24:27], v[84:87], v[104:107], v[24:27]
  ds_read_b128 v[72:75], v5 offset:14336
  v_mfma_f32_16x16x32_bf16 v[44:47], v[84:87], v[108:111], v[44:47]
  v_mfma_f32_16x16x32_bf16 v[28:31], v[88:91], v[104:107], v[28:31]
  v_mfma_f32_16x16x32_bf16 v[48:51], v[88:91], v[108:111], v[48:51]
  v_mfma_f32_16x16x32_bf16 v[32:35], v[92:95], v[104:107], v[32:35]
  v_mfma_f32_16x16x32_bf16 v[52:55], v[92:95], v[108:111], v[52:55]
  s_waitcnt vmcnt(18) lgkmcnt(0)
  v_mfma_f32_16x16x32_bf16 v[16:19], v[56:59], v[112:115], v[16:19]
  ds_read_b128 v[76:79], v5 offset:15360
  v_mfma_f32_16x16x32_bf16 v[36:39], v[56:59], v[116:119], v[36:39]
  ds_read_b128 v[80:83], v5 offset:16384
  v_mfma_f32_16x16x32_bf16 v[20:23], v[60:63], v[112:115], v[20:23]
  ds_read_b128 v[84:87], v5 offset:17408
  v_mfma_f32_16x16x32_bf16 v[40:43], v[60:63], v[116:119], v[40:43]
  ds_read_b128 v[88:91], v5 offset:18432
  v_mfma_f32_16x16x32_bf16 v[24:27], v[64:67], v[112:115], v[24:27]
  ds_read_b128 v[92:95], v5 offset:19456
  v_mfma_f32_16x16x32_bf16 v[44:47], v[64:67], v[116:119], v[44:47]
  v_mfma_f32_16x16x32_bf16 v[28:31], v[68:71], v[112:115], v[28:31]
  v_mfma_f32_16x16x32_bf16 v[48:51], v[68:71], v[116:119], v[48:51]
  v_mfma_f32_16x16x32_bf16 v[32:35], v[72:75], v[112:115], v[32:35]
  v_mfma_f32_16x16x32_bf16 v[52:55], v[72:75], v[116:119], v[52:55]
  s_waitcnt vmcnt(16) lgkmcnt(0)
  s_barrier
  v_mfma_f32_16x16x32_bf16 v[16:19], v[76:79], v[120:123], v[16:19]
  ds_read_b128 v[56:59], v5 offset:20480
  v_mfma_f32_16x16x32_bf16 v[36:39], v[76:79], v[124:127], v[36:39]
  ds_read_b128 v[60:63], v5 offset:21504
  v_mfma_f32_16x16x32_bf16 v[20:23], v[80:83], v[120:123], v[20:23]
  ds_read_b128 v[64:67], v5 offset:22528
  v_mfma_f32_16x16x32_bf16 v[40:43], v[80:83], v[124:127], v[40:43]
  ds_read_b128 v[68:71], v5 offset:23552
  v_mfma_f32_16x16x32_bf16 v[24:27], v[84:87], v[120:123], v[24:27]
  ds_read_b128 v[72:75], v5 offset:24576
  v_mfma_f32_16x16x32_bf16 v[44:47], v[84:87], v[124:127], v[44:47]
  v_mfma_f32_16x16x32_bf16 v[28:31], v[88:91], v[120:123], v[28:31]
  v_mfma_f32_16x16x32_bf16 v[48:51], v[88:91], v[124:127], v[48:51]
  v_mfma_f32_16x16x32_bf16 v[32:35], v[92:95], v[120:123], v[32:35]
  v_mfma_f32_16x16x32_bf16 v[52:55], v[92:95], v[124:127], v[52:55]
  s_waitcnt vmcnt(12) lgkmcnt(0)
  v_mfma_f32_16x16x32_bf16 v[16:19], v[56:59], v[128:131], v[16:19]
  ds_read_b128 v[76:79], v5 offset:25600
  v_mfma_f32_16x16x32_bf16 v[36:39], v[56:59], v[132:135], v[36:39]
  ds_read_b128 v[80:83], v5 offset:26624
  v_mfma_f32_16x16x32_bf16 v[20:23], v[60:63], v[128:131], v[20:23]
  ds_read_b128 v[84:87], v5 offset:27648
  v_mfma_f32_16x16x32_bf16 v[40:43], v[60:63], v[132:135], v[40:43]
  ds_read_b128 v[88:91], v5 offset:28672
  v_mfma_f32_16x16x32_bf16 v[24:27], v[64:67], v[128:131], v[24:27]
  ds_read_b128 v[92:95], v5 offset:29696
  v_mfma_f32_16x16x32_bf16 v[44:47], v[64:67], v[132:135], v[44:47]
  v_mfma_f32_16x16x32_bf16 v[28:31], v[68:71], v[128:131], v[28:31]
  v_mfma_f32_16x16x32_bf16 v[48:51], v[68:71], v[132:135], v[48:51]
  v_mfma_f32_16x16x32_bf16 v[32:35], v[72:75], v[128:131], v[32:35]
  v_mfma_f32_16x16x32_bf16 v[52:55], v[72:75], v[132:135], v[52:55]
  s_waitcnt vmcnt(8) lgkmcnt(0)
  v_mfma_f32_16x16x32_bf16 v[16:19], v[76:79], v[136:139], v[16:19]
  ds_read_b128 v[56:59], v5 offset:30720
  v_mfma_f32_16x16x32_bf16 v[36:39], v[76:79], v[140:143], v[36:39]
  ds_read_b128 v[60:63], v5 offset:31744
  v_mfma_f32_16x16x32_bf16 v[20:23], v[80:83], v[136:139], v[20:23]
  ds_read_b128 v[64:67], v5 offset:32768
  v_mfma_f32_16x16x32_bf16 v[40:43], v[80:83], v[140:143], v[40:43]
  ds_read_b128 v[68:71], v5 offset:33792
  v_mfma_f32_16x16x32_bf16 v[24:27], v[84:87], v[136:139], v[24:27]
  ds_read_b128 v[72:75], v5 offset:34816
  v_mfma_f32_16x16x32_bf16 v[44:47], v[84:87], v[140:143], v[44:47]
  v_mfma_f32_16x16x32_bf16 v[28:31], v[88:91], v[136:139], v[28:31]
  v_mfma_f32_16x16x32_bf16 v[48:51], v[88:91], v[140:143], v[48:51]
  v_mfma_f32_16x16x32_bf16 v[32:35], v[92:95], v[136:139], v[32:35]
  v_mfma_f32_16x16x32_bf16 v[52:55], v[92:95], v[140:143], v[52:55]
  s_waitcnt vmcnt(4) lgkmcnt(0)
  v_mfma_f32_16x16x32_bf16 v[16:19], v[56:59], v[144:147], v[16:19]
  ds_read_b128 v[76:79], v5 offset:35840
  v_mfma_f32_16x16x32_bf16 v[36:39], v[56:59], v[148:151], v[36:39]
  ds_read_b128 v[80:83], v5 offset:36864
  v_mfma_f32_16x16x32_bf16 v[20:23], v[60:63], v[144:147], v[20:23]
  ds_read_b128 v[84:87], v5 offset:37888
  v_mfma_f32_16x16x32_bf16 v[40:43], v[60:63], v[148:151], v[40:43]
  ds_read_b128 v[88:91], v5 offset:38912
  v_mfma_f32_16x16x32_bf16 v[24:27], v[64:67], v[144:147], v[24:27]
  ds_read_b128 v[92:95], v5 offset:39936
  v_mfma_f32_16x16x32_bf16 v[44:47], v[64:67], v[148:151], v[44:47]
  v_mfma_f32_16x16x32_bf16 v[28:31], v[68:71], v[144:147], v[28:31]
  v_mfma_f32_16x16x32_bf16 v[48:51], v[68:71], v[148:151], v[48:51]
  v_mfma_f32_16x16x32_bf16 v[32:35], v[72:75], v[144:147], v[32:35]
  v_mfma_f32_16x16x32_bf16 v[52:55], v[72:75], v[148:151], v[52:55]
  s_waitcnt vmcnt(0) lgkmcnt(0)
  v_mfma_f32_16x16x32_bf16 v[16:19], v[76:79], v[152:155], v[16:19]
  v_mfma_f32_16x16x32_bf16 v[36:39], v[76:79], v[156:159], v[36:39]
  v_mfma_f32_16x16x32_bf16 v[20:23], v[80:83], v[152:155], v[20:23]
  v_mfma_f32_16x16x32_bf16 v[40:43], v[80:83], v[156:159], v[40:43]
  v_mfma_f32_16x16x32_bf16 v[24:27], v[84:87], v[152:155], v[24:27]
  v_mfma_f32_16x16x32_bf16 v[44:47], v[84:87], v[156:159], v[44:47]
  v_mfma_f32_16x16x32_bf16 v[28:31], v[88:91], v[152:155], v[28:31]
  v_mfma_f32_16x16x32_bf16 v[48:51], v[88:91], v[156:159], v[48:51]
  v_mfma_f32_16x16x32_bf16 v[32:35], v[92:95], v[152:155], v[32:35]
  v_mfma_f32_16x16x32_bf16 v[52:55], v[92:95], v[156:159], v[52:55]
  s_nop 7
  s_mov_b32 s32, 40960
  v_cvt_pk_bf16_f32 v16, v16, v17
  v_cvt_pk_bf16_f32 v17, v18, v19
  v_cvt_pk_bf16_f32 v18, v20, v21
  v_cvt_pk_bf16_f32 v19, v22, v23
  v_cvt_pk_bf16_f32 v36, v36, v37
  v_cvt_pk_bf16_f32 v37, v38, v39
  v_cvt_pk_bf16_f32 v38, v40, v41
  v_cvt_pk_bf16_f32 v39, v42, v43
  v_cvt_pk_bf16_f32 v24, v24, v25
  v_cvt_pk_bf16_f32 v25, v26, v27
  v_cvt_pk_bf16_f32 v26, v28, v29
  v_cvt_pk_bf16_f32 v27, v30, v31
  v_cvt_pk_bf16_f32 v44, v44, v45
  v_cvt_pk_bf16_f32 v45, v46, v47
  v_cvt_pk_bf16_f32 v46, v48, v49
  v_cvt_pk_bf16_f32 v47, v50, v51
  v_cvt_pk_bf16_f32 v32, v32, v33
  v_cvt_pk_bf16_f32 v33, v34, v35
  v_cvt_pk_bf16_f32 v34, v52, v53
  v_cvt_pk_bf16_f32 v35, v54, v55
  v_permlane16_swap_b32 v16, v18
  v_permlane16_swap_b32 v17, v19
  buffer_store_dwordx4 v[16:19], v11, s[16:19], 0 offen offset:0
  v_permlane16_swap_b32 v36, v38
  v_permlane16_swap_b32 v37, v39
  buffer_store_dwordx4 v[36:39], v11, s[16:19], s32 offen offset:0
  v_permlane16_swap_b32 v24, v26
  v_permlane16_swap_b32 v25, v27
  buffer_store_dwordx4 v[24:27], v11, s[16:19], 0 offen offset:64
  v_permlane16_swap_b32 v44, v46
  v_permlane16_swap_b32 v45, v47
  buffer_store_dwordx4 v[44:47], v11, s[16:19], s32 offen offset:64
  v_permlane16_swap_b32 v32, v34
  v_permlane16_swap_b32 v33, v35
  buffer_store_dwordx4 v[32:35], v4, s[16:19], 0 offen offset:128
  s_endpgm
L_outp_kernel_end:
  s_endpgm
.section .rodata,"a"
.p2align 6
.amdhsa_kernel proj_kernel
  .amdhsa_next_free_vgpr 192
  .amdhsa_next_free_sgpr 96
  .amdhsa_accum_offset 192
  .amdhsa_group_segment_fixed_size 0
  .amdhsa_kernarg_size 88
  .amdhsa_user_sgpr_count 2
  .amdhsa_user_sgpr_kernarg_segment_ptr 1
  .amdhsa_system_sgpr_workgroup_id_x 1
  .amdhsa_float_denorm_mode_32 3
.end_amdhsa_kernel
.section .rodata,"a"
.p2align 6
.amdhsa_kernel attn_kernel
  .amdhsa_next_free_vgpr 224
  .amdhsa_next_free_sgpr 96
  .amdhsa_accum_offset 224
  .amdhsa_group_segment_fixed_size 0
  .amdhsa_kernarg_size 88
  .amdhsa_user_sgpr_count 2
  .amdhsa_user_sgpr_kernarg_segment_ptr 1
  .amdhsa_system_sgpr_workgroup_id_x 1
  .amdhsa_float_denorm_mode_32 3
.end_amdhsa_kernel
.section .rodata,"a"
.p2align 6
.amdhsa_kernel outp_kernel
  .amdhsa_next_free_vgpr 196
  .amdhsa_next_free_sgpr 96
  .amdhsa_accum_offset 196
  .amdhsa_group_segment_fixed_size 0
  .amdhsa_kernarg_size 88
  .amdhsa_user_sgpr_count 2
  .amdhsa_user_sgpr_kernarg_segment_ptr 1
  .amdhsa_system_sgpr_workgroup_id_x 1
  .amdhsa_float_denorm_mode_32 3
.end_amdhsa_kernel
```
